```python
import torch

def _softmax(x, axis=-1):
    return torch.softmax(x, dim=axis)
def _gelu(x):
    return torch.nn.functional.gelu(x, approximate="tanh")
def _silu(x):
    return torch.nn.functional.silu(x)
def _sigmoid(x):
    return torch.sigmoid(x)
def _layernorm(x, axis=-1, eps=1e-5):
    m = x.mean(dim=axis, keepdim=True)
    v = x.var(dim=axis, keepdim=True, unbiased=False)
    return (x - m) / torch.sqrt(v + eps)
def _scatter_add(tgt, idx, src, axis=0):
    return tgt.clone().index_add_(axis, idx, src)
def _segment_sum(src, seg, n):
    out = torch.zeros((n,) + src.shape[1:], dtype=src.dtype)
    return out.index_add_(0, seg, src)
def _pad(x, pw):
    flat = tuple(v for pair in reversed(pw) for v in pair)
    return torch.nn.functional.pad(x, flat)

kernel_name = 'concat_heads__mha_block_cached__mha_block_cached__near_ridge'

def setup_inputs():

    _w = (lambda a: (lambda t: t.to(torch.bfloat16) if t.is_floating_point() else t)(torch.as_tensor(a)))
    def _A_setup():
        B, Sq, D = 8, 112, 512
        H, Sk, Dh = 32, 512, 128
        return {
            "x": _w((lambda *s: torch.randn(*s, dtype=torch.bfloat16) * 0.8)(B, Sq, D)),
            "k_cache": _w((lambda *s: torch.randn(*s, dtype=torch.bfloat16) * 0.8)(B, H, Sk, Dh)),
            "v_cache": _w((lambda *s: torch.randn(*s, dtype=torch.bfloat16) * 0.05)(B, H, Sk, Dh)),
            "wq": _w((lambda *s: torch.randn(*s, dtype=torch.bfloat16) * 0.8)(D, H * Dh) * (D ** -0.5)),
            "wo": _w((lambda *s: torch.randn(*s, dtype=torch.bfloat16) * 0.05)(H * Dh, D) * ((H * Dh) ** -0.5)),
        }
    _A_in = _A_setup()

    def _B_setup():
        B, Sq, D = 8, 112, 512
        H, Sk, Dh = 32, 512, 128
        return {
            "x": _w((lambda *s: torch.randn(*s, dtype=torch.bfloat16) * 0.8)(B, Sq, D)),
            "k_cache": _w((lambda *s: torch.randn(*s, dtype=torch.bfloat16) * 0.8)(B, H, Sk, Dh)),
            "v_cache": _w((lambda *s: torch.randn(*s, dtype=torch.bfloat16) * 0.05)(B, H, Sk, Dh)),
            "wq": _w((lambda *s: torch.randn(*s, dtype=torch.bfloat16) * 0.8)(D, H * Dh) * (D ** -0.5)),
            "wo": _w((lambda *s: torch.randn(*s, dtype=torch.bfloat16) * 0.05)(H * Dh, D) * ((H * Dh) ** -0.5)),
        }
    _B_in = _B_setup()

    return {
        "A_x": _A_in["x"],
        "A_k_cache": _A_in["k_cache"],
        "A_v_cache": _A_in["v_cache"],
        "A_wq": _A_in["wq"],
        "A_wo": _A_in["wo"],
        "B_x": _B_in["x"],
        "B_k_cache": _B_in["k_cache"],
        "B_v_cache": _B_in["v_cache"],
        "B_wq": _B_in["wq"],
        "B_wo": _B_in["wo"],
    }

def reference(A_x, A_k_cache, A_v_cache, A_wq, A_wo, B_x, B_k_cache, B_v_cache, B_wq, B_wo):
    def _A_ref(x, k_cache, v_cache, wq, wo):
        B, Sq, D = x.shape
        H, Dh = 32, 128
        q = (lambda x, *d: x.permute(*d))((x @ wq).reshape(B, Sq, H, Dh), 0, 2, 1, 3)
        scores = torch.einsum("bhqd,bhkd->bhqk", q, k_cache) * (Dh ** -0.5)
        p = _softmax(scores, axis=-1)
        o = torch.einsum("bhqk,bhkd->bhqd", p, v_cache)
        return (lambda x, *d: x.permute(*d))(o, 0, 2, 1, 3).reshape(B, Sq, H * Dh) @ wo

    def _B_ref(x, k_cache, v_cache, wq, wo):
        B, Sq, D = x.shape
        H, Dh = 32, 128
        q = (lambda x, *d: x.permute(*d))((x @ wq).reshape(B, Sq, H, Dh), 0, 2, 1, 3)
        scores = torch.einsum("bhqd,bhkd->bhqk", q, k_cache) * (Dh ** -0.5)
        p = _softmax(scores, axis=-1)
        o = torch.einsum("bhqk,bhkd->bhqd", p, v_cache)
        return (lambda x, *d: x.permute(*d))(o, 0, 2, 1, 3).reshape(B, Sq, H * Dh) @ wo

    a = _A_ref(A_x, A_k_cache, A_v_cache, A_wq, A_wo)
    b = _B_ref(B_x, B_k_cache, B_v_cache, B_wq, B_wo)
    return torch.concatenate([a, b], axis=-1)
```

```asm
; @launch grid=(256,1,1) block=(512,1,1) lds=163840
.amdgcn_target "amdgcn-amd-amdhsa--gfx950"
.text
.globl concat_heads__mha_block_cached__mha_block_cached__near_ridge_kernel
.p2align 8
.type concat_heads__mha_block_cached__mha_block_cached__near_ridge_kernel,@function
concat_heads__mha_block_cached__mha_block_cached__near_ridge_kernel:
  s_cmp_ge_u32 s2, 256
  s_cbranch_scc1 L_end
  s_load_dwordx16 s[36:51], s[0:1], 0
  s_load_dwordx8 s[52:59], s[0:1], 64
  s_load_dwordx2 s[60:61], s[0:1], 96
  v_lshrrev_b32 v1, 6, v0
  s_and_b32 s70, s2, 7
  s_lshr_b32 s71, s2, 3
  s_getpc_b64 s[84:85]
L_pc:
  s_sub_u32 s84, s84, L_pc-concat_heads__mha_block_cached__mha_block_cached__near_ridge_kernel
  s_subb_u32 s85, s85, 0
  v_lshlrev_b32 v2, 7, v1
  v_and_b32 v3, 31, v0
  v_lshlrev_b32 v3, 2, v3
  v_add_u32 v2, v2, v3
  v_and_b32 v3, 32, v0
  v_lshlrev_b32 v3, 10, v3
  v_add_u32 v2, v2, v3
  s_lshl_b32 s72, s71, 10
  v_add_u32 v2, s72, v2
  v_min_u32 v2, L_end-concat_heads__mha_block_cached__mha_block_cached__near_ridge_kernel, v2
  v_and_b32 v25, 63, v0
  global_load_dword v0, v2, s[84:85]
  v_readfirstlane_b32 s62, v1
  s_lshr_b32 s64, s70, 2
  s_and_b32 s65, s70, 3
  s_and_b32 s66, s71, 7
  s_lshr_b32 s67, s71, 3
  s_lshl_b32 s68, s65, 3
  s_lshl_b32 s70, s67, 1
  s_add_u32 s68, s68, s70
  s_add_u32 s78, s66, s70
  s_and_b32 s63, s62, 3
  s_lshl_b32 s81, s63, 12
  v_mov_b32 v1, v25
  v_lshrrev_b32 v19, 4, v1
  v_and_b32 v20, 15, v1
  v_lshlrev_b32 v21, 2, v19
  v_xor_b32 v21, v20, v21
  v_lshlrev_b32 v21, 4, v21
  v_lshrrev_b32 v17, 5, v1
  v_and_b32 v18, 3, v1
  v_lshlrev_b32 v2, 13, v19
  v_add_u32 v2, v2, v21
  v_lshrrev_b32 v22, 3, v1
  v_lshlrev_b32 v22, 10, v22
  v_and_b32 v23, 7, v1
  v_xor_b32 v23, v23, v19
  v_lshlrev_b32 v24, 4, v23
  v_add_u32 v3, v22, v24
  v_xor_b32 v24, 64, v24
  v_add_u32 v4, v22, v24
  s_mov_b32 s6, 33554432
  s_mov_b32 s7, 0x20000
  s_mov_b32 s10, 33554432
  s_mov_b32 s11, 0x20000
  s_mov_b32 s14, 4194304
  s_mov_b32 s15, 0x20000
  s_mov_b32 s22, 268435456
  s_mov_b32 s23, 0x20000
  s_mov_b32 s26, 4194304
  s_mov_b32 s27, 0x20000
  s_mov_b32 s30, 1835008
  s_mov_b32 s31, 0x20000
  s_mov_b32 s34, 256
  s_mov_b32 s35, 0x20000
  s_mov_b32 s19, 0x20000
  s_lshl_b32 s70, s63, 17
  s_lshl_b32 s71, s68, 8
  s_add_u32 s82, s70, s71
  s_mul_i32 s70, s66, 112
  s_add_u32 s71, s70, 112
  s_lshl_b32 s18, s71, 10
  s_lshl_b32 s71, s63, 5
  s_add_u32 s70, s70, s71
  s_lshl_b32 s72, s70, 10
  s_lshl_b32 s70, s66, 5
  s_add_u32 s70, s70, s68
  s_lshl_b32 s69, s70, 17
  s_add_u32 s83, s69, s81
  s_cmp_eq_u32 s64, 0
  s_waitcnt lgkmcnt(0)
  s_cselect_b32 s16, s36, s46
  s_cselect_b32 s17, s37, s47
  s_cselect_b32 s12, s42, s52
  s_cselect_b32 s13, s43, s53
  s_cselect_b32 s4, s38, s48
  s_cselect_b32 s5, s39, s49
  s_cselect_b32 s8, s40, s50
  s_cselect_b32 s9, s41, s51
  s_cselect_b32 s24, s44, s54
  s_cselect_b32 s25, s45, s55
  s_mov_b32 s28, s56
  s_mov_b32 s29, s57
  s_mov_b32 s32, s58
  s_mov_b32 s33, s59
  s_mov_b32 s20, s60
  s_mov_b32 s21, s61
  s_cmp_ge_u32 s62, 4
  s_cbranch_scc1 L_B
  s_add_u32 s87, s78, 0
  s_and_b32 s87, s87, 7
  s_lshl_b32 s87, s87, 7
  s_add_u32 s87, s87, s72
  s_add_u32 m0, s81, 32768
  s_add_u32 s71, s87, 0
  buffer_load_dwordx4 v3, s[16:19], s71 offen offset:0 lds
  s_add_u32 s71, s87, 7168
  buffer_load_dwordx4 v4, s[16:19], s71 offen offset:1024 lds
  s_add_u32 s71, s87, 14336
  buffer_load_dwordx4 v3, s[16:19], s71 offen offset:2048 lds
  s_add_u32 s71, s87, 21504
  buffer_load_dwordx4 v4, s[16:19], s71 offen offset:3072 lds
  s_add_u32 s87, s78, 0
  s_and_b32 s87, s87, 7
  s_lshl_b32 s87, s87, 19
  s_add_u32 s87, s87, s82
  s_add_u32 m0, s81, 49152
  s_add_u32 s71, s87, 0
  buffer_load_dwordx4 v2, s[12:15], s71 offen offset:0 nt lds
  s_add_u32 s71, s87, 31744
  buffer_load_dwordx4 v2, s[12:15], s71 offen offset:1024 nt lds
  s_add_u32 s71, s87, 63488
  buffer_load_dwordx4 v2, s[12:15], s71 offen offset:2048 nt lds
  s_add_u32 s71, s87, 95232
  buffer_load_dwordx4 v2, s[12:15], s71 offen offset:3072 nt lds
  s_add_u32 s87, s78, 1
  s_and_b32 s87, s87, 7
  s_lshl_b32 s87, s87, 7
  s_add_u32 s87, s87, s72
  s_add_u32 m0, s81, 65536
  s_add_u32 s71, s87, 0
  buffer_load_dwordx4 v3, s[16:19], s71 offen offset:0 lds
  s_add_u32 s71, s87, 7168
  buffer_load_dwordx4 v4, s[16:19], s71 offen offset:1024 lds
  s_add_u32 s71, s87, 14336
  buffer_load_dwordx4 v3, s[16:19], s71 offen offset:2048 lds
  s_add_u32 s71, s87, 21504
  buffer_load_dwordx4 v4, s[16:19], s71 offen offset:3072 lds
  s_add_u32 s87, s78, 1
  s_and_b32 s87, s87, 7
  s_lshl_b32 s87, s87, 19
  s_add_u32 s87, s87, s82
  s_add_u32 m0, s81, 81920
  s_add_u32 s71, s87, 0
  buffer_load_dwordx4 v2, s[12:15], s71 offen offset:0 lds
  s_add_u32 s71, s87, 31744
  buffer_load_dwordx4 v2, s[12:15], s71 offen offset:1024 lds
  s_add_u32 s71, s87, 63488
  buffer_load_dwordx4 v2, s[12:15], s71 offen offset:2048 lds
  s_add_u32 s71, s87, 95232
  buffer_load_dwordx4 v2, s[12:15], s71 offen offset:3072 lds
  s_waitcnt vmcnt(8)
  s_barrier
  s_add_u32 s87, s78, 2
  s_and_b32 s87, s87, 7
  s_lshl_b32 s87, s87, 7
  s_add_u32 s87, s87, s72
  s_add_u32 m0, s81, 98304
  s_add_u32 s71, s87, 0
  buffer_load_dwordx4 v3, s[16:19], s71 offen offset:0 lds
  s_add_u32 s71, s87, 7168
  buffer_load_dwordx4 v4, s[16:19], s71 offen offset:1024 lds
  s_add_u32 s71, s87, 14336
  buffer_load_dwordx4 v3, s[16:19], s71 offen offset:2048 lds
  s_add_u32 s71, s87, 21504
  buffer_load_dwordx4 v4, s[16:19], s71 offen offset:3072 lds
  s_add_u32 s87, s78, 2
  s_and_b32 s87, s87, 7
  s_lshl_b32 s87, s87, 19
  s_add_u32 s87, s87, s82
  s_add_u32 m0, s81, 114688
  s_add_u32 s71, s87, 0
  buffer_load_dwordx4 v2, s[12:15], s71 offen offset:0 lds
  s_add_u32 s71, s87, 31744
  buffer_load_dwordx4 v2, s[12:15], s71 offen offset:1024 lds
  s_add_u32 s71, s87, 63488
  buffer_load_dwordx4 v2, s[12:15], s71 offen offset:2048 lds
  s_add_u32 s71, s87, 95232
  buffer_load_dwordx4 v2, s[12:15], s71 offen offset:3072 lds
  s_lshl_b32 s70, s64, 3
  s_add_u32 s70, s70, s66
  s_lshl_b32 s71, s70, 5
  s_add_u32 s71, s71, s68
  s_mul_i32 s80, s71, 28672
  s_lshl_b32 s71, s70, 2
  s_add_u32 s71, s71, s65
  s_lshl_b32 s85, s71, 2
  s_add_u32 s86, s85, s67
  s_cmp_eq_u32 s63, 3
  s_cselect_b32 s88, 0xffff, -1
  s_mov_b32 s89, s88
  v_lshlrev_b32 v22, 8, v19
  v_add_u32 v9, v22, v21
  v_add_u32 v23, 0, v19
  v_xor_b32 v23, v20, v23
  v_lshlrev_b32 v23, 4, v23
  v_add_u32 v5, v22, v23
  v_add_u32 v23, 4, v19
  v_xor_b32 v23, v20, v23
  v_lshlrev_b32 v23, 4, v23
  v_add_u32 v6, v22, v23
  v_add_u32 v23, 8, v19
  v_xor_b32 v23, v20, v23
  v_lshlrev_b32 v23, 4, v23
  v_add_u32 v7, v22, v23
  v_add_u32 v23, 12, v19
  v_xor_b32 v23, v20, v23
  v_lshlrev_b32 v23, 4, v23
  v_add_u32 v8, v22, v23
  s_waitcnt vmcnt(8)
  s_barrier
  s_add_u32 s87, s78, 3
  s_and_b32 s87, s87, 7
  s_lshl_b32 s87, s87, 7
  s_add_u32 s87, s87, s72
  s_add_u32 m0, s81, 131072
  s_add_u32 s71, s87, 0
  buffer_load_dwordx4 v3, s[16:19], s71 offen offset:0 lds
  s_add_u32 s71, s87, 7168
  buffer_load_dwordx4 v4, s[16:19], s71 offen offset:1024 lds
  s_add_u32 s71, s87, 14336
  buffer_load_dwordx4 v3, s[16:19], s71 offen offset:2048 lds
  s_add_u32 s71, s87, 21504
  buffer_load_dwordx4 v4, s[16:19], s71 offen offset:3072 lds
  s_add_u32 s87, s78, 3
  s_and_b32 s87, s87, 7
  s_lshl_b32 s87, s87, 19
  s_add_u32 s87, s87, s82
  s_add_u32 m0, s81, 147456
  s_add_u32 s71, s87, 0
  buffer_load_dwordx4 v2, s[12:15], s71 offen offset:0 lds
  s_add_u32 s71, s87, 31744
  buffer_load_dwordx4 v2, s[12:15], s71 offen offset:1024 lds
  s_add_u32 s71, s87, 63488
  buffer_load_dwordx4 v2, s[12:15], s71 offen offset:2048 lds
  s_add_u32 s71, s87, 95232
  buffer_load_dwordx4 v2, s[12:15], s71 offen offset:3072 lds
  v_and_b32 v10, 31, v1
  v_lshlrev_b32 v10, 8, v10
  v_xor_b32 v11, v17, v20
  v_xor_b32 v12, 0, v11
  v_lshlrev_b32 v12, 4, v12
  v_add_u32 v224, v10, v12
  v_xor_b32 v12, 2, v11
  v_lshlrev_b32 v12, 4, v12
  v_add_u32 v225, v10, v12
  v_xor_b32 v12, 4, v11
  v_lshlrev_b32 v12, 4, v12
  v_add_u32 v226, v10, v12
  v_xor_b32 v12, 6, v11
  v_lshlrev_b32 v12, 4, v12
  v_add_u32 v227, v10, v12
  v_xor_b32 v12, 8, v11
  v_lshlrev_b32 v12, 4, v12
  v_add_u32 v228, v10, v12
  v_xor_b32 v12, 10, v11
  v_lshlrev_b32 v12, 4, v12
  v_add_u32 v229, v10, v12
  v_xor_b32 v12, 12, v11
  v_lshlrev_b32 v12, 4, v12
  v_add_u32 v230, v10, v12
  v_xor_b32 v12, 14, v11
  v_lshlrev_b32 v12, 4, v12
  v_add_u32 v231, v10, v12
  s_waitcnt vmcnt(8)
  s_barrier
  s_add_u32 s87, s78, 4
  s_and_b32 s87, s87, 7
  s_lshl_b32 s87, s87, 7
  s_add_u32 s87, s87, s72
  s_add_u32 m0, s81, 32768
  s_add_u32 s71, s87, 0
  buffer_load_dwordx4 v3, s[16:19], s71 offen offset:0 lds
  s_add_u32 s71, s87, 7168
  buffer_load_dwordx4 v4, s[16:19], s71 offen offset:1024 lds
  s_add_u32 s71, s87, 14336
  buffer_load_dwordx4 v3, s[16:19], s71 offen offset:2048 lds
  s_add_u32 s71, s87, 21504
  buffer_load_dwordx4 v4, s[16:19], s71 offen offset:3072 lds
  s_add_u32 s87, s78, 4
  s_and_b32 s87, s87, 7
  s_lshl_b32 s87, s87, 19
  s_add_u32 s87, s87, s82
  s_add_u32 m0, s81, 49152
  s_add_u32 s71, s87, 0
  buffer_load_dwordx4 v2, s[12:15], s71 offen offset:0 lds
  s_add_u32 s71, s87, 31744
  buffer_load_dwordx4 v2, s[12:15], s71 offen offset:1024 lds
  s_add_u32 s71, s87, 63488
  buffer_load_dwordx4 v2, s[12:15], s71 offen offset:2048 lds
  s_add_u32 s71, s87, 95232
  buffer_load_dwordx4 v2, s[12:15], s71 offen offset:3072 lds
  v_lshrrev_b32 v10, 2, v20
  v_and_b32 v11, 1, v19
  v_lshlrev_b32 v12, 10, v17
  v_lshlrev_b32 v13, 8, v10
  v_add_u32 v12, v12, v13
  v_lshlrev_b32 v13, 5, v11
  v_add_u32 v12, v12, v13
  v_and_b32 v13, 1, v18
  v_lshlrev_b32 v13, 4, v13
  v_add_u32 v12, v12, v13
  v_lshrrev_b32 v13, 1, v18
  v_lshlrev_b32 v13, 3, v13
  v_add_u32 v12, v12, v13
  v_add_u32 v12, 16384, v12
  v_xor_b32 v13, 0, v10
  v_lshlrev_b32 v13, 6, v13
  v_add_u32 v232, v12, v13
  v_xor_b32 v13, 1, v10
  v_lshlrev_b32 v13, 6, v13
  v_add_u32 v233, v12, v13
  v_xor_b32 v13, 2, v10
  v_lshlrev_b32 v13, 6, v13
  v_add_u32 v234, v12, v13
  v_xor_b32 v13, 3, v10
  v_lshlrev_b32 v13, 6, v13
  v_add_u32 v235, v12, v13
  s_waitcnt vmcnt(8)
  s_barrier
  s_add_u32 s87, s78, 5
  s_and_b32 s87, s87, 7
  s_lshl_b32 s87, s87, 7
  s_add_u32 s87, s87, s72
  s_add_u32 m0, s81, 65536
  s_add_u32 s71, s87, 0
  buffer_load_dwordx4 v3, s[16:19], s71 offen offset:0 lds
  s_add_u32 s71, s87, 7168
  buffer_load_dwordx4 v4, s[16:19], s71 offen offset:1024 lds
  s_add_u32 s71, s87, 14336
  buffer_load_dwordx4 v3, s[16:19], s71 offen offset:2048 lds
  s_add_u32 s71, s87, 21504
  buffer_load_dwordx4 v4, s[16:19], s71 offen offset:3072 lds
  s_add_u32 s87, s78, 5
  s_and_b32 s87, s87, 7
  s_lshl_b32 s87, s87, 19
  s_add_u32 s87, s87, s82
  s_add_u32 m0, s81, 81920
  s_add_u32 s71, s87, 0
  buffer_load_dwordx4 v2, s[12:15], s71 offen offset:0 lds
  s_add_u32 s71, s87, 31744
  buffer_load_dwordx4 v2, s[12:15], s71 offen offset:1024 lds
  s_add_u32 s71, s87, 63488
  buffer_load_dwordx4 v2, s[12:15], s71 offen offset:2048 lds
  s_add_u32 s71, s87, 95232
  buffer_load_dwordx4 v2, s[12:15], s71 offen offset:3072 lds
  s_lshl_b32 s70, s63, 13
  s_add_u32 s70, s70, 98304
  v_lshlrev_b32 v236, 4, v1
  v_add_u32 v236, s70, v236
  v_mul_u32_u24 v237, 112, v17
  v_and_b32 v12, 31, v1
  v_add_u32 v237, v237, v12
  s_lshl_b32 s70, s63, 5
  v_add_u32 v237, s70, v237
  v_lshlrev_b32 v237, 4, v237
  v_mov_b64 v[208:209], 0
  v_mov_b64 v[210:211], 0
  v_mov_b64 v[212:213], 0
  v_mov_b64 v[214:215], 0
  v_mov_b64 v[216:217], 0
  v_mov_b64 v[218:219], 0
  v_mov_b64 v[220:221], 0
  v_mov_b64 v[222:223], 0
  v_mov_b64 v[240:241], 0
  s_mov_b32 s74, 0x183
  s_mov_b32 s76, 0x4924
  s_mov_b32 s79, 0xffff0000
  s_mov_b32 s3, 32768
  s_mov_b32 s75, 0x41400000
  s_mov_b32 s77, 0
  s_mov_b32 s73, 0
  s_add_u32 s80, s80, 28672
  s_waitcnt vmcnt(8)
  s_barrier
  s_add_u32 s87, s78, 6
  s_and_b32 s87, s87, 7
  s_lshl_b32 s87, s87, 7
  s_add_u32 s87, s87, s72
  s_add_u32 m0, s81, 98304
  s_add_u32 s71, s87, 0
  buffer_load_dwordx4 v3, s[16:19], s71 offen offset:0 lds
  s_add_u32 s71, s87, 7168
  buffer_load_dwordx4 v4, s[16:19], s71 offen offset:1024 lds
  s_add_u32 s71, s87, 14336
  buffer_load_dwordx4 v3, s[16:19], s71 offen offset:2048 lds
  s_add_u32 s71, s87, 21504
  buffer_load_dwordx4 v4, s[16:19], s71 offen offset:3072 lds
  s_add_u32 s87, s78, 6
  s_and_b32 s87, s87, 7
  s_lshl_b32 s87, s87, 19
  s_add_u32 s87, s87, s82
  s_add_u32 m0, s81, 114688
  s_add_u32 s71, s87, 0
  buffer_load_dwordx4 v2, s[12:15], s71 offen offset:0 lds
  s_add_u32 s71, s87, 31744
  buffer_load_dwordx4 v2, s[12:15], s71 offen offset:1024 lds
  s_add_u32 s71, s87, 63488
  buffer_load_dwordx4 v2, s[12:15], s71 offen offset:2048 lds
  s_add_u32 s71, s87, 95232
  buffer_load_dwordx4 v2, s[12:15], s71 offen offset:3072 lds
  s_waitcnt vmcnt(8)
  s_barrier
  s_add_u32 s87, s78, 7
  s_and_b32 s87, s87, 7
  s_lshl_b32 s87, s87, 7
  s_add_u32 s87, s87, s72
  s_add_u32 m0, s81, 131072
  s_add_u32 s71, s87, 0
  buffer_load_dwordx4 v3, s[16:19], s71 offen offset:0 lds
  s_add_u32 s71, s87, 7168
  buffer_load_dwordx4 v4, s[16:19], s71 offen offset:1024 lds
  s_add_u32 s71, s87, 14336
  buffer_load_dwordx4 v3, s[16:19], s71 offen offset:2048 lds
  s_add_u32 s71, s87, 21504
  buffer_load_dwordx4 v4, s[16:19], s71 offen offset:3072 lds
  s_add_u32 s87, s78, 7
  s_and_b32 s87, s87, 7
  s_lshl_b32 s87, s87, 19
  s_add_u32 s87, s87, s82
  s_add_u32 m0, s81, 147456
  s_add_u32 s71, s87, 0
  buffer_load_dwordx4 v2, s[12:15], s71 offen offset:0 lds
  s_add_u32 s71, s87, 31744
  buffer_load_dwordx4 v2, s[12:15], s71 offen offset:1024 lds
  s_add_u32 s71, s87, 63488
  buffer_load_dwordx4 v2, s[12:15], s71 offen offset:2048 lds
  s_add_u32 s71, s87, 95232
  buffer_load_dwordx4 v2, s[12:15], s71 offen offset:3072 lds
  s_add_u32 m0, s81, 0
  s_add_u32 s70, s83, 0
  buffer_load_dwordx4 v5, s[4:7], s70 offen offset:0 nt lds
  buffer_load_dwordx4 v6, s[4:7], s70 offen offset:1024 nt lds
  buffer_load_dwordx4 v7, s[4:7], s70 offen offset:2048 nt lds
  buffer_load_dwordx4 v8, s[4:7], s70 offen offset:3072 nt lds
  s_add_u32 s87, s78, 0
  s_and_b32 s87, s87, 7
  s_lshl_b32 s87, s87, 19
  s_add_u32 s87, s87, s82
  s_add_u32 m0, s81, 16384
  s_add_u32 s71, s87, 256
  buffer_load_dwordx4 v2, s[12:15], s71 offen offset:0 nt lds
  s_add_u32 s71, s87, 32000
  buffer_load_dwordx4 v2, s[12:15], s71 offen offset:1024 nt lds
  s_add_u32 s71, s87, 63744
  buffer_load_dwordx4 v2, s[12:15], s71 offen offset:2048 nt lds
  s_add_u32 s71, s87, 95488
  buffer_load_dwordx4 v2, s[12:15], s71 offen offset:3072 nt lds
  s_waitcnt vmcnt(16)
  s_barrier
  s_waitcnt vmcnt(8)
  s_barrier
  s_add_u32 m0, s81, 32768
  s_add_u32 s70, s83, 16384
  buffer_load_dwordx4 v5, s[4:7], s70 offen offset:0 nt lds
  buffer_load_dwordx4 v6, s[4:7], s70 offen offset:1024 nt lds
  buffer_load_dwordx4 v7, s[4:7], s70 offen offset:2048 nt lds
  buffer_load_dwordx4 v8, s[4:7], s70 offen offset:3072 nt lds
  s_add_u32 m0, s81, 49152
  s_add_u32 s70, s83, 0
  buffer_load_dwordx4 v9, s[8:11], s70 offen offset:0 nt lds
  buffer_load_dwordx4 v9, s[8:11], s70 offen offset:1024 nt lds
  buffer_load_dwordx4 v9, s[8:11], s70 offen offset:2048 nt lds
  buffer_load_dwordx4 v9, s[8:11], s70 offen offset:3072 nt lds
A_loop:
  s_bitcmp1_b32 s74, s77
  s_cbranch_scc1 A_tope
  s_barrier
A_toper:
  ds_read_b128 v[176:179], v224 offset:0
  ds_read_b128 v[180:183], v225 offset:0
  ds_read_b128 v[184:187], v226 offset:0
  ds_read_b128 v[188:191], v227 offset:0
  ds_read_b128 v[192:195], v228 offset:0
  ds_read_b128 v[196:199], v229 offset:0
  ds_read_b128 v[200:203], v230 offset:0
  ds_read_b128 v[204:207], v231 offset:0
  v_cvt_pk_bf16_f32 v96, v64, v65
  v_add_f32 v240, v240, v64
  v_add_f32 v241, v241, v65
  v_cvt_pk_bf16_f32 v97, v66, v67
  v_add_f32 v240, v240, v66
  v_add_f32 v241, v241, v67
  v_cvt_pk_bf16_f32 v98, v68, v69
  v_add_f32 v240, v240, v68
  v_add_f32 v241, v241, v69
  v_cvt_pk_bf16_f32 v99, v70, v71
  v_add_f32 v240, v240, v70
  v_add_f32 v241, v241, v71
  v_cvt_pk_bf16_f32 v100, v72, v73
  v_add_f32 v240, v240, v72
  v_add_f32 v241, v241, v73
  v_cvt_pk_bf16_f32 v101, v74, v75
  v_add_f32 v240, v240, v74
  v_add_f32 v241, v241, v75
  v_cvt_pk_bf16_f32 v102, v76, v77
  v_add_f32 v240, v240, v76
  v_add_f32 v241, v241, v77
  v_cvt_pk_bf16_f32 v103, v78, v79
  v_add_f32 v240, v240, v78
  v_add_f32 v241, v241, v79
  v_exp_f32 v80, v80
  v_exp_f32 v81, v81
  v_exp_f32 v82, v82
  s_waitcnt lgkmcnt(6)
  v_mfma_f32_32x32x16_bf16 v[32:47], v[176:179], v[0:3], v[208:223]
  ds_read_b128 v[176:179], v224 offset:8192
  v_exp_f32 v83, v83
  v_add_f32 v240, v240, v80
  v_exp_f32 v84, v84
  v_mfma_f32_32x32x16_bf16 v[32:47], v[180:183], v[4:7], v[32:47]
  ds_read_b128 v[180:183], v225 offset:8192
  v_add_f32 v241, v241, v81
  v_exp_f32 v85, v85
  v_add_f32 v240, v240, v82
  s_waitcnt lgkmcnt(6)
  v_mfma_f32_32x32x16_bf16 v[32:47], v[184:187], v[8:11], v[32:47]
  ds_read_b128 v[184:187], v226 offset:8192
  v_cvt_pk_bf16_f32 v104, v80, v81
  v_exp_f32 v86, v86
  v_mfma_f32_32x32x16_bf16 v[32:47], v[188:191], v[12:15], v[32:47]
  ds_read_b128 v[188:191], v227 offset:8192
  v_add_f32 v241, v241, v83
  v_exp_f32 v87, v87
  v_add_f32 v240, v240, v84
  s_waitcnt lgkmcnt(6)
  v_mfma_f32_32x32x16_bf16 v[32:47], v[192:195], v[16:19], v[32:47]
  ds_read_b128 v[192:195], v228 offset:8192
  v_cvt_pk_bf16_f32 v105, v82, v83
  v_exp_f32 v88, v88
  v_add_f32 v241, v241, v85
  v_mfma_f32_32x32x16_bf16 v[32:47], v[196:199], v[20:23], v[32:47]
  ds_read_b128 v[196:199], v229 offset:8192
  v_exp_f32 v89, v89
  v_add_f32 v240, v240, v86
  s_waitcnt lgkmcnt(6)
  v_mfma_f32_32x32x16_bf16 v[32:47], v[200:203], v[24:27], v[32:47]
  ds_read_b128 v[200:203], v230 offset:8192
  v_cvt_pk_bf16_f32 v106, v84, v85
  v_exp_f32 v90, v90
  v_add_f32 v241, v241, v87
  v_mfma_f32_32x32x16_bf16 v[32:47], v[204:207], v[28:31], v[32:47]
  ds_read_b128 v[204:207], v231 offset:8192
  v_exp_f32 v91, v91
  v_add_f32 v240, v240, v88
  v_cvt_pk_bf16_f32 v107, v86, v87
  s_waitcnt lgkmcnt(6)
  v_mfma_f32_32x32x16_bf16 v[48:63], v[176:179], v[0:3], v[208:223]
  v_exp_f32 v92, v92
  v_add_f32 v241, v241, v89
  v_mfma_f32_32x32x16_bf16 v[48:63], v[180:183], v[4:7], v[48:63]
  ds_read_b64_tr_b16 v[176:177], v232 offset:0
  ds_read_b64_tr_b16 v[178:179], v232 offset:2048
  v_exp_f32 v93, v93
  v_add_f32 v240, v240, v90
  v_cvt_pk_bf16_f32 v108, v88, v89
  s_waitcnt lgkmcnt(6)
  v_mfma_f32_32x32x16_bf16 v[48:63], v[184:187], v[8:11], v[48:63]
  ds_read_b64_tr_b16 v[180:181], v233 offset:0
  ds_read_b64_tr_b16 v[182:183], v233 offset:2048
  v_exp_f32 v94, v94
  v_add_f32 v241, v241, v91
  v_exp_f32 v95, v95
  v_max3_f32 v248, v32, v33, v34
  v_max3_f32 v249, v40, v41, v42
  v_mfma_f32_32x32x16_bf16 v[48:63], v[188:191], v[12:15], v[48:63]
  ds_read_b64_tr_b16 v[184:185], v234 offset:0
  ds_read_b64_tr_b16 v[186:187], v234 offset:2048
  v_add_f32 v240, v240, v92
  v_cvt_pk_bf16_f32 v109, v90, v91
  v_max3_f32 v248, v248, v35, v36
  s_waitcnt lgkmcnt(8)
  v_mfma_f32_32x32x16_bf16 v[48:63], v[192:195], v[16:19], v[48:63]
  ds_read_b64_tr_b16 v[188:189], v235 offset:0
  ds_read_b64_tr_b16 v[190:191], v235 offset:2048
  v_add_f32 v241, v241, v93
  v_cvt_pk_bf16_f32 v110, v92, v93
  v_add_f32 v240, v240, v94
  v_max3_f32 v249, v249, v43, v44
  v_mfma_f32_32x32x16_bf16 v[48:63], v[196:199], v[20:23], v[48:63]
  ds_read_b64_tr_b16 v[192:193], v232 offset:4096
  ds_read_b64_tr_b16 v[194:195], v232 offset:6144
  v_add_f32 v241, v241, v95
  v_cvt_pk_bf16_f32 v111, v94, v95
  v_max3_f32 v248, v248, v37, v38
  s_waitcnt lgkmcnt(10)
  v_mfma_f32_32x32x16_bf16 v[48:63], v[200:203], v[24:27], v[48:63]
  ds_read_b64_tr_b16 v[196:197], v233 offset:4096
  ds_read_b64_tr_b16 v[198:199], v233 offset:6144
  v_max3_f32 v249, v249, v45, v46
  v_mfma_f32_32x32x16_bf16 v[48:63], v[204:207], v[28:31], v[48:63]
  ds_read_b64_tr_b16 v[200:201], v234 offset:4096
  ds_read_b64_tr_b16 v[202:203], v234 offset:6144
  v_max3_f32 v248, v248, v39, v47
  s_bitcmp1_b32 s76, s77
  s_cselect_b32 s70, s79, s3
  s_waitcnt lgkmcnt(10)
  v_mfma_f32_32x32x16_bf16 v[112:127], v[176:179], v[96:99], v[112:127]
  ds_read_b64_tr_b16 v[204:205], v235 offset:4096
  ds_read_b64_tr_b16 v[206:207], v235 offset:6144
  v_add_u32 v224, s70, v224
  v_add_u32 v225, s70, v225
  v_mfma_f32_32x32x16_bf16 v[128:143], v[180:183], v[96:99], v[128:143]
  ds_read_b64_tr_b16 v[176:177], v232 offset:8192
  ds_read_b64_tr_b16 v[178:179], v232 offset:10240
  v_add_u32 v226, s70, v226
  v_add_u32 v227, s70, v227
  s_waitcnt lgkmcnt(10)
  v_mfma_f32_32x32x16_bf16 v[144:159], v[184:187], v[96:99], v[144:159]
  ds_read_b64_tr_b16 v[180:181], v233 offset:8192
  ds_read_b64_tr_b16 v[182:183], v233 offset:10240
  v_max3_f32 v250, v48, v49, v50
  v_max3_f32 v251, v56, v57, v58
  v_max3_f32 v250, v250, v51, v52
  v_mfma_f32_32x32x16_bf16 v[160:175], v[188:191], v[96:99], v[160:175]
  ds_read_b64_tr_b16 v[184:185], v234 offset:8192
  ds_read_b64_tr_b16 v[186:187], v234 offset:10240
  v_max3_f32 v251, v251, v59, v60
  v_max3_f32 v250, v250, v53, v54
  v_max3_f32 v251, v251, v61, v62
  s_waitcnt lgkmcnt(10)
  v_mfma_f32_32x32x16_bf16 v[112:127], v[192:195], v[100:103], v[112:127]
  ds_read_b64_tr_b16 v[188:189], v235 offset:8192
  ds_read_b64_tr_b16 v[190:191], v235 offset:10240
  v_max3_f32 v250, v250, v55, v63
  v_max3_f32 v248, v248, v249, v250
  v_max_f32 v248, v248, v251
  v_mfma_f32_32x32x16_bf16 v[128:143], v[196:199], v[100:103], v[128:143]
  ds_read_b64_tr_b16 v[192:193], v232 offset:12288
  ds_read_b64_tr_b16 v[194:195], v232 offset:14336
  v_cmp_lt_f32 vcc, s75, v248
  s_nop 0
  s_cbranch_vccnz A_resce
A_rescer:
  v_exp_f32 v32, v32
  v_exp_f32 v33, v33
  s_waitcnt lgkmcnt(10)
  v_mfma_f32_32x32x16_bf16 v[144:159], v[200:203], v[100:103], v[144:159]
  ds_read_b64_tr_b16 v[196:197], v233 offset:12288
  ds_read_b64_tr_b16 v[198:199], v233 offset:14336
  v_exp_f32 v34, v34
  v_add_u32 v228, s70, v228
  v_mfma_f32_32x32x16_bf16 v[160:175], v[204:207], v[100:103], v[160:175]
  ds_read_b64_tr_b16 v[200:201], v234 offset:12288
  ds_read_b64_tr_b16 v[202:203], v234 offset:14336
  v_exp_f32 v35, v35
  v_exp_f32 v36, v36
  v_add_u32 v229, s70, v229
  s_waitcnt lgkmcnt(10)
  v_mfma_f32_32x32x16_bf16 v[112:127], v[176:179], v[104:107], v[112:127]
  ds_read_b64_tr_b16 v[204:205], v235 offset:12288
  ds_read_b64_tr_b16 v[206:207], v235 offset:14336
  v_exp_f32 v37, v37
  v_add_u32 v230, s70, v230
  v_mfma_f32_32x32x16_bf16 v[128:143], v[180:183], v[104:107], v[128:143]
  v_exp_f32 v38, v38
  v_exp_f32 v39, v39
  v_add_u32 v231, s70, v231
  s_waitcnt lgkmcnt(8)
  v_mfma_f32_32x32x16_bf16 v[144:159], v[184:187], v[104:107], v[144:159]
  v_exp_f32 v40, v40
  v_add_u32 v232, s70, v232
  v_mfma_f32_32x32x16_bf16 v[160:175], v[188:191], v[104:107], v[160:175]
  v_exp_f32 v41, v41
  v_exp_f32 v42, v42
  v_add_u32 v233, s70, v233
  s_waitcnt lgkmcnt(4)
  v_mfma_f32_32x32x16_bf16 v[112:127], v[192:195], v[108:111], v[112:127]
  v_exp_f32 v43, v43
  v_add_u32 v234, s70, v234
  v_mfma_f32_32x32x16_bf16 v[128:143], v[196:199], v[108:111], v[128:143]
  v_exp_f32 v44, v44
  v_exp_f32 v45, v45
  v_add_u32 v235, s70, v235
  s_waitcnt lgkmcnt(0)
  v_mfma_f32_32x32x16_bf16 v[144:159], v[200:203], v[108:111], v[144:159]
  v_exp_f32 v46, v46
  v_mfma_f32_32x32x16_bf16 v[160:175], v[204:207], v[108:111], v[160:175]
  v_exp_f32 v47, v47
  s_cmp_lg_u32 s73, 0
  s_cbranch_scc1 A_pende
A_pender:
  s_add_u32 s77, s77, 1
A_par1:
  s_bitcmp1_b32 s74, s77
  s_cbranch_scc1 A_topo
  s_barrier
A_topor:
  ds_read_b128 v[176:179], v224 offset:0
  ds_read_b128 v[180:183], v225 offset:0
  ds_read_b128 v[184:187], v226 offset:0
  ds_read_b128 v[188:191], v227 offset:0
  ds_read_b128 v[192:195], v228 offset:0
  ds_read_b128 v[196:199], v229 offset:0
  ds_read_b128 v[200:203], v230 offset:0
  ds_read_b128 v[204:207], v231 offset:0
  v_cvt_pk_bf16_f32 v96, v32, v33
  v_add_f32 v240, v240, v32
  v_add_f32 v241, v241, v33
  v_cvt_pk_bf16_f32 v97, v34, v35
  v_add_f32 v240, v240, v34
  v_add_f32 v241, v241, v35
  v_cvt_pk_bf16_f32 v98, v36, v37
  v_add_f32 v240, v240, v36
  v_add_f32 v241, v241, v37
  v_cvt_pk_bf16_f32 v99, v38, v39
  v_add_f32 v240, v240, v38
  v_add_f32 v241, v241, v39
  v_cvt_pk_bf16_f32 v100, v40, v41
  v_add_f32 v240, v240, v40
  v_add_f32 v241, v241, v41
  v_cvt_pk_bf16_f32 v101, v42, v43
  v_add_f32 v240, v240, v42
  v_add_f32 v241, v241, v43
  v_cvt_pk_bf16_f32 v102, v44, v45
  v_add_f32 v240, v240, v44
  v_add_f32 v241, v241, v45
  v_cvt_pk_bf16_f32 v103, v46, v47
  v_add_f32 v240, v240, v46
  v_add_f32 v241, v241, v47
  v_exp_f32 v48, v48
  v_exp_f32 v49, v49
  v_exp_f32 v50, v50
  s_waitcnt lgkmcnt(6)
  v_mfma_f32_32x32x16_bf16 v[64:79], v[176:179], v[0:3], v[208:223]
  ds_read_b128 v[176:179], v224 offset:8192
  v_exp_f32 v51, v51
  v_add_f32 v240, v240, v48
  v_exp_f32 v52, v52
  v_mfma_f32_32x32x16_bf16 v[64:79], v[180:183], v[4:7], v[64:79]
  ds_read_b128 v[180:183], v225 offset:8192
  v_add_f32 v241, v241, v49
  v_exp_f32 v53, v53
  v_add_f32 v240, v240, v50
  s_waitcnt lgkmcnt(6)
  v_mfma_f32_32x32x16_bf16 v[64:79], v[184:187], v[8:11], v[64:79]
  ds_read_b128 v[184:187], v226 offset:8192
  v_cvt_pk_bf16_f32 v104, v48, v49
  v_exp_f32 v54, v54
  v_mfma_f32_32x32x16_bf16 v[64:79], v[188:191], v[12:15], v[64:79]
  ds_read_b128 v[188:191], v227 offset:8192
  v_add_f32 v241, v241, v51
  v_exp_f32 v55, v55
  v_add_f32 v240, v240, v52
  s_waitcnt lgkmcnt(6)
  v_mfma_f32_32x32x16_bf16 v[64:79], v[192:195], v[16:19], v[64:79]
  ds_read_b128 v[192:195], v228 offset:8192
  v_cvt_pk_bf16_f32 v105, v50, v51
  v_exp_f32 v56, v56
  v_add_f32 v241, v241, v53
  v_mfma_f32_32x32x16_bf16 v[64:79], v[196:199], v[20:23], v[64:79]
  ds_read_b128 v[196:199], v229 offset:8192
  v_exp_f32 v57, v57
  v_add_f32 v240, v240, v54
  s_waitcnt lgkmcnt(6)
  v_mfma_f32_32x32x16_bf16 v[64:79], v[200:203], v[24:27], v[64:79]
  ds_read_b128 v[200:203], v230 offset:8192
  v_cvt_pk_bf16_f32 v106, v52, v53
  v_exp_f32 v58, v58
  v_add_f32 v241, v241, v55
  v_mfma_f32_32x32x16_bf16 v[64:79], v[204:207], v[28:31], v[64:79]
  ds_read_b128 v[204:207], v231 offset:8192
  v_exp_f32 v59, v59
  v_add_f32 v240, v240, v56
  v_cvt_pk_bf16_f32 v107, v54, v55
  s_waitcnt lgkmcnt(6)
  v_mfma_f32_32x32x16_bf16 v[80:95], v[176:179], v[0:3], v[208:223]
  v_exp_f32 v60, v60
  v_add_f32 v241, v241, v57
  v_mfma_f32_32x32x16_bf16 v[80:95], v[180:183], v[4:7], v[80:95]
  ds_read_b64_tr_b16 v[176:177], v232 offset:0
  ds_read_b64_tr_b16 v[178:179], v232 offset:2048
  v_exp_f32 v61, v61
  v_add_f32 v240, v240, v58
  v_cvt_pk_bf16_f32 v108, v56, v57
  s_waitcnt lgkmcnt(6)
  v_mfma_f32_32x32x16_bf16 v[80:95], v[184:187], v[8:11], v[80:95]
  ds_read_b64_tr_b16 v[180:181], v233 offset:0
  ds_read_b64_tr_b16 v[182:183], v233 offset:2048
  v_exp_f32 v62, v62
  v_add_f32 v241, v241, v59
  v_exp_f32 v63, v63
  v_max3_f32 v248, v64, v65, v66
  v_max3_f32 v249, v72, v73, v74
  v_mfma_f32_32x32x16_bf16 v[80:95], v[188:191], v[12:15], v[80:95]
  ds_read_b64_tr_b16 v[184:185], v234 offset:0
  ds_read_b64_tr_b16 v[186:187], v234 offset:2048
  v_add_f32 v240, v240, v60
  v_cvt_pk_bf16_f32 v109, v58, v59
  v_max3_f32 v248, v248, v67, v68
  s_waitcnt lgkmcnt(8)
  v_mfma_f32_32x32x16_bf16 v[80:95], v[192:195], v[16:19], v[80:95]
  ds_read_b64_tr_b16 v[188:189], v235 offset:0
  ds_read_b64_tr_b16 v[190:191], v235 offset:2048
  v_add_f32 v241, v241, v61
  v_cvt_pk_bf16_f32 v110, v60, v61
  v_add_f32 v240, v240, v62
  v_max3_f32 v249, v249, v75, v76
  v_mfma_f32_32x32x16_bf16 v[80:95], v[196:199], v[20:23], v[80:95]
  ds_read_b64_tr_b16 v[192:193], v232 offset:4096
  ds_read_b64_tr_b16 v[194:195], v232 offset:6144
  v_add_f32 v241, v241, v63
  v_cvt_pk_bf16_f32 v111, v62, v63
  v_max3_f32 v248, v248, v69, v70
  s_waitcnt lgkmcnt(10)
  v_mfma_f32_32x32x16_bf16 v[80:95], v[200:203], v[24:27], v[80:95]
  ds_read_b64_tr_b16 v[196:197], v233 offset:4096
  ds_read_b64_tr_b16 v[198:199], v233 offset:6144
  v_max3_f32 v249, v249, v77, v78
  v_mfma_f32_32x32x16_bf16 v[80:95], v[204:207], v[28:31], v[80:95]
  ds_read_b64_tr_b16 v[200:201], v234 offset:4096
  ds_read_b64_tr_b16 v[202:203], v234 offset:6144
  v_max3_f32 v248, v248, v71, v79
  s_bitcmp1_b32 s76, s77
  s_cselect_b32 s70, s79, s3
  s_waitcnt lgkmcnt(10)
  v_mfma_f32_32x32x16_bf16 v[112:127], v[176:179], v[96:99], v[112:127]
  ds_read_b64_tr_b16 v[204:205], v235 offset:4096
  ds_read_b64_tr_b16 v[206:207], v235 offset:6144
  v_add_u32 v224, s70, v224
  v_add_u32 v225, s70, v225
  v_mfma_f32_32x32x16_bf16 v[128:143], v[180:183], v[96:99], v[128:143]
  ds_read_b64_tr_b16 v[176:177], v232 offset:8192
  ds_read_b64_tr_b16 v[178:179], v232 offset:10240
  v_add_u32 v226, s70, v226
  v_add_u32 v227, s70, v227
  s_waitcnt lgkmcnt(10)
  v_mfma_f32_32x32x16_bf16 v[144:159], v[184:187], v[96:99], v[144:159]
  ds_read_b64_tr_b16 v[180:181], v233 offset:8192
  ds_read_b64_tr_b16 v[182:183], v233 offset:10240
  v_max3_f32 v250, v80, v81, v82
  v_max3_f32 v251, v88, v89, v90
  v_max3_f32 v250, v250, v83, v84
  v_mfma_f32_32x32x16_bf16 v[160:175], v[188:191], v[96:99], v[160:175]
  ds_read_b64_tr_b16 v[184:185], v234 offset:8192
  ds_read_b64_tr_b16 v[186:187], v234 offset:10240
  v_max3_f32 v251, v251, v91, v92
  v_max3_f32 v250, v250, v85, v86
  v_max3_f32 v251, v251, v93, v94
  s_waitcnt lgkmcnt(10)
  v_mfma_f32_32x32x16_bf16 v[112:127], v[192:195], v[100:103], v[112:127]
  ds_read_b64_tr_b16 v[188:189], v235 offset:8192
  ds_read_b64_tr_b16 v[190:191], v235 offset:10240
  v_max3_f32 v250, v250, v87, v95
  v_max3_f32 v248, v248, v249, v250
  v_max_f32 v248, v248, v251
  v_mfma_f32_32x32x16_bf16 v[128:143], v[196:199], v[100:103], v[128:143]
  ds_read_b64_tr_b16 v[192:193], v232 offset:12288
  ds_read_b64_tr_b16 v[194:195], v232 offset:14336
  v_cmp_lt_f32 vcc, s75, v248
  s_nop 0
  s_cbranch_vccnz A_resco
A_rescor:
  v_exp_f32 v64, v64
  v_exp_f32 v65, v65
  s_waitcnt lgkmcnt(10)
  v_mfma_f32_32x32x16_bf16 v[144:159], v[200:203], v[100:103], v[144:159]
  ds_read_b64_tr_b16 v[196:197], v233 offset:12288
  ds_read_b64_tr_b16 v[198:199], v233 offset:14336
  v_exp_f32 v66, v66
  v_add_u32 v228, s70, v228
  v_mfma_f32_32x32x16_bf16 v[160:175], v[204:207], v[100:103], v[160:175]
  ds_read_b64_tr_b16 v[200:201], v234 offset:12288
  ds_read_b64_tr_b16 v[202:203], v234 offset:14336
  v_exp_f32 v67, v67
  v_exp_f32 v68, v68
  v_add_u32 v229, s70, v229
  s_waitcnt lgkmcnt(10)
  v_mfma_f32_32x32x16_bf16 v[112:127], v[176:179], v[104:107], v[112:127]
  ds_read_b64_tr_b16 v[204:205], v235 offset:12288
  ds_read_b64_tr_b16 v[206:207], v235 offset:14336
  v_exp_f32 v69, v69
  v_add_u32 v230, s70, v230
  v_mfma_f32_32x32x16_bf16 v[128:143], v[180:183], v[104:107], v[128:143]
  v_exp_f32 v70, v70
  v_exp_f32 v71, v71
  v_add_u32 v231, s70, v231
  s_waitcnt lgkmcnt(8)
  v_mfma_f32_32x32x16_bf16 v[144:159], v[184:187], v[104:107], v[144:159]
  v_exp_f32 v72, v72
  v_add_u32 v232, s70, v232
  v_mfma_f32_32x32x16_bf16 v[160:175], v[188:191], v[104:107], v[160:175]
  v_exp_f32 v73, v73
  v_exp_f32 v74, v74
  v_add_u32 v233, s70, v233
  s_waitcnt lgkmcnt(4)
  v_mfma_f32_32x32x16_bf16 v[112:127], v[192:195], v[108:111], v[112:127]
  v_exp_f32 v75, v75
  v_add_u32 v234, s70, v234
  v_mfma_f32_32x32x16_bf16 v[128:143], v[196:199], v[108:111], v[128:143]
  v_exp_f32 v76, v76
  v_exp_f32 v77, v77
  v_add_u32 v235, s70, v235
  s_waitcnt lgkmcnt(0)
  v_mfma_f32_32x32x16_bf16 v[144:159], v[200:203], v[108:111], v[144:159]
  v_exp_f32 v78, v78
  v_mfma_f32_32x32x16_bf16 v[160:175], v[204:207], v[108:111], v[160:175]
  v_exp_f32 v79, v79
  s_cmp_lg_u32 s73, 0
  s_cbranch_scc1 A_pendo
A_pendor:
  s_add_u32 s77, s77, 1
  s_cmp_lt_u32 s77, 16
  s_cbranch_scc1 A_loop
  s_barrier
  ds_read_b64_tr_b16 v[176:177], v232 offset:0
  ds_read_b64_tr_b16 v[178:179], v232 offset:2048
  ds_read_b64_tr_b16 v[180:181], v232 offset:4096
  ds_read_b64_tr_b16 v[182:183], v232 offset:6144
  ds_read_b64_tr_b16 v[184:185], v232 offset:8192
  ds_read_b64_tr_b16 v[186:187], v232 offset:10240
  ds_read_b64_tr_b16 v[188:189], v232 offset:12288
  ds_read_b64_tr_b16 v[190:191], v232 offset:14336
  ds_read_b64_tr_b16 v[192:193], v233 offset:0
  ds_read_b64_tr_b16 v[194:195], v233 offset:2048
  ds_read_b64_tr_b16 v[196:197], v233 offset:4096
  ds_read_b64_tr_b16 v[198:199], v233 offset:6144
  ds_read_b64_tr_b16 v[200:201], v233 offset:8192
  ds_read_b64_tr_b16 v[202:203], v233 offset:10240
  v_cvt_pk_bf16_f32 v96, v64, v65
  v_add_f32 v240, v240, v64
  v_add_f32 v241, v241, v65
  v_cvt_pk_bf16_f32 v97, v66, v67
  v_add_f32 v240, v240, v66
  v_add_f32 v241, v241, v67
  v_cvt_pk_bf16_f32 v98, v68, v69
  v_add_f32 v240, v240, v68
  v_add_f32 v241, v241, v69
  v_cvt_pk_bf16_f32 v99, v70, v71
  v_add_f32 v240, v240, v70
  v_add_f32 v241, v241, v71
  v_cvt_pk_bf16_f32 v100, v72, v73
  v_add_f32 v240, v240, v72
  v_add_f32 v241, v241, v73
  v_cvt_pk_bf16_f32 v101, v74, v75
  v_add_f32 v240, v240, v74
  v_add_f32 v241, v241, v75
  v_cvt_pk_bf16_f32 v102, v76, v77
  v_add_f32 v240, v240, v76
  v_add_f32 v241, v241, v77
  v_cvt_pk_bf16_f32 v103, v78, v79
  v_add_f32 v240, v240, v78
  v_add_f32 v241, v241, v79
  v_exp_f32 v80, v80
  v_exp_f32 v81, v81
  v_exp_f32 v82, v82
  v_exp_f32 v83, v83
  v_add_f32 v240, v240, v80
  v_exp_f32 v84, v84
  v_add_f32 v241, v241, v81
  v_exp_f32 v85, v85
  v_add_f32 v240, v240, v82
  v_cvt_pk_bf16_f32 v104, v80, v81
  v_exp_f32 v86, v86
  v_add_f32 v241, v241, v83
  v_exp_f32 v87, v87
  v_add_f32 v240, v240, v84
  v_cvt_pk_bf16_f32 v105, v82, v83
  v_exp_f32 v88, v88
  v_add_f32 v241, v241, v85
  v_exp_f32 v89, v89
  v_add_f32 v240, v240, v86
  v_cvt_pk_bf16_f32 v106, v84, v85
  v_exp_f32 v90, v90
  v_add_f32 v241, v241, v87
  v_exp_f32 v91, v91
  v_add_f32 v240, v240, v88
  v_cvt_pk_bf16_f32 v107, v86, v87
  v_exp_f32 v92, v92
  v_add_f32 v241, v241, v89
  v_exp_f32 v93, v93
  v_add_f32 v240, v240, v90
  v_cvt_pk_bf16_f32 v108, v88, v89
  v_exp_f32 v94, v94
  v_add_f32 v241, v241, v91
  v_exp_f32 v95, v95
  v_add_f32 v240, v240, v92
  v_cvt_pk_bf16_f32 v109, v90, v91
  v_add_f32 v241, v241, v93
  v_cvt_pk_bf16_f32 v110, v92, v93
  v_add_f32 v240, v240, v94
  v_add_f32 v241, v241, v95
  v_cvt_pk_bf16_f32 v111, v94, v95
  v_add_f32 v244, v240, v241
  v_mov_b32 v245, v244
  s_nop 1
  v_permlane32_swap_b32 v244, v245
  v_add_f32 v244, v244, v245
  v_rcp_f32 v242, v244
  v_add_u32 v236, 0xfffe4000, v236
  s_waitcnt lgkmcnt(10)
  v_mfma_f32_32x32x16_bf16 v[112:127], v[176:179], v[96:99], v[112:127]
  ds_read_b64_tr_b16 v[204:205], v233 offset:12288
  ds_read_b64_tr_b16 v[206:207], v233 offset:14336
  v_mfma_f32_32x32x16_bf16 v[112:127], v[180:183], v[100:103], v[112:127]
  ds_read_b64_tr_b16 v[176:177], v234 offset:0
  ds_read_b64_tr_b16 v[178:179], v234 offset:2048
  s_waitcnt lgkmcnt(10)
  v_mfma_f32_32x32x16_bf16 v[112:127], v[184:187], v[104:107], v[112:127]
  ds_read_b64_tr_b16 v[180:181], v234 offset:4096
  ds_read_b64_tr_b16 v[182:183], v234 offset:6144
  v_mfma_f32_32x32x16_bf16 v[112:127], v[188:191], v[108:111], v[112:127]
  ds_read_b64_tr_b16 v[184:185], v234 offset:8192
  ds_read_b64_tr_b16 v[186:187], v234 offset:10240
  s_waitcnt lgkmcnt(10)
  v_mfma_f32_32x32x16_bf16 v[128:143], v[192:195], v[96:99], v[128:143]
  ds_read_b64_tr_b16 v[188:189], v234 offset:12288
  ds_read_b64_tr_b16 v[190:191], v234 offset:14336
  v_mfma_f32_32x32x16_bf16 v[128:143], v[196:199], v[100:103], v[128:143]
  ds_read_b64_tr_b16 v[192:193], v235 offset:0
  ds_read_b64_tr_b16 v[194:195], v235 offset:2048
  s_waitcnt lgkmcnt(10)
  v_mfma_f32_32x32x16_bf16 v[128:143], v[200:203], v[104:107], v[128:143]
  ds_read_b64_tr_b16 v[196:197], v235 offset:4096
  ds_read_b64_tr_b16 v[198:199], v235 offset:6144
  v_mul_f32 v112, v242, v112
  v_mul_f32 v113, v242, v113
  v_mul_f32 v114, v242, v114
  v_mul_f32 v115, v242, v115
  v_mul_f32 v116, v242, v116
  v_mul_f32 v117, v242, v117
  v_mul_f32 v118, v242, v118
  v_mfma_f32_32x32x16_bf16 v[128:143], v[204:207], v[108:111], v[128:143]
  ds_read_b64_tr_b16 v[200:201], v235 offset:8192
  ds_read_b64_tr_b16 v[202:203], v235 offset:10240
  v_mul_f32 v119, v242, v119
  v_mul_f32 v120, v242, v120
  v_mul_f32 v121, v242, v121
  v_mul_f32 v122, v242, v122
  v_mul_f32 v123, v242, v123
  v_mul_f32 v124, v242, v124
  s_waitcnt lgkmcnt(10)
  v_mfma_f32_32x32x16_bf16 v[144:159], v[176:179], v[96:99], v[144:159]
  ds_read_b64_tr_b16 v[204:205], v235 offset:12288
  ds_read_b64_tr_b16 v[206:207], v235 offset:14336
  v_mul_f32 v125, v242, v125
  v_mul_f32 v126, v242, v126
  v_mul_f32 v127, v242, v127
  v_cvt_pk_bf16_f32 v32, v112, v113
  v_cvt_pk_bf16_f32 v33, v114, v115
  v_cvt_pk_bf16_f32 v34, v116, v117
  v_mfma_f32_32x32x16_bf16 v[144:159], v[180:183], v[100:103], v[144:159]
  v_cvt_pk_bf16_f32 v35, v118, v119
  v_cvt_pk_bf16_f32 v36, v120, v121
  v_cvt_pk_bf16_f32 v37, v122, v123
  v_cvt_pk_bf16_f32 v38, v124, v125
  v_cvt_pk_bf16_f32 v39, v126, v127
  ds_write_b128 v236, v[32:35] offset:0
  ds_write_b128 v236, v[36:39] offset:1024
  s_mov_b64 exec, s[88:89]
  s_add_u32 s71, s80, 0
  buffer_store_dwordx4 v[32:35], v237, s[20:23], s71 offen sc1
  s_add_u32 s71, s80, 3584
  buffer_store_dwordx4 v[36:39], v237, s[20:23], s71 offen sc1
  s_mov_b64 exec, -1
  s_waitcnt lgkmcnt(8)
  v_mfma_f32_32x32x16_bf16 v[144:159], v[184:187], v[104:107], v[144:159]
  v_mul_f32 v128, v242, v128
  v_mul_f32 v129, v242, v129
  v_mul_f32 v130, v242, v130
  v_mul_f32 v131, v242, v131
  v_mul_f32 v132, v242, v132
  v_mul_f32 v133, v242, v133
  v_mul_f32 v134, v242, v134
  v_mfma_f32_32x32x16_bf16 v[144:159], v[188:191], v[108:111], v[144:159]
  v_mul_f32 v135, v242, v135
  v_mul_f32 v136, v242, v136
  v_mul_f32 v137, v242, v137
  v_mul_f32 v138, v242, v138
  v_mul_f32 v139, v242, v139
  v_mul_f32 v140, v242, v140
  s_waitcnt lgkmcnt(4)
  v_mfma_f32_32x32x16_bf16 v[160:175], v[192:195], v[96:99], v[160:175]
  v_mul_f32 v141, v242, v141
  v_mul_f32 v142, v242, v142
  v_mul_f32 v143, v242, v143
  v_cvt_pk_bf16_f32 v40, v128, v129
  v_cvt_pk_bf16_f32 v41, v130, v131
  v_cvt_pk_bf16_f32 v42, v132, v133
  v_mfma_f32_32x32x16_bf16 v[160:175], v[196:199], v[100:103], v[160:175]
  v_cvt_pk_bf16_f32 v43, v134, v135
  v_cvt_pk_bf16_f32 v44, v136, v137
  v_cvt_pk_bf16_f32 v45, v138, v139
  v_cvt_pk_bf16_f32 v46, v140, v141
  v_cvt_pk_bf16_f32 v47, v142, v143
  ds_write_b128 v236, v[40:43] offset:2048
  ds_write_b128 v236, v[44:47] offset:3072
  s_mov_b64 exec, s[88:89]
  s_add_u32 s71, s80, 7168
  buffer_store_dwordx4 v[40:43], v237, s[20:23], s71 offen sc1
  s_add_u32 s71, s80, 10752
  buffer_store_dwordx4 v[44:47], v237, s[20:23], s71 offen sc1
  s_mov_b64 exec, -1
  s_waitcnt lgkmcnt(0)
  v_mfma_f32_32x32x16_bf16 v[160:175], v[200:203], v[104:107], v[160:175]
  v_mul_f32 v144, v242, v144
  v_mul_f32 v145, v242, v145
  v_mul_f32 v146, v242, v146
  v_mul_f32 v147, v242, v147
  v_mul_f32 v148, v242, v148
  v_mul_f32 v149, v242, v149
  v_mul_f32 v150, v242, v150
  v_mul_f32 v151, v242, v151
  v_mul_f32 v152, v242, v152
  v_mul_f32 v153, v242, v153
  v_mul_f32 v154, v242, v154
  v_mul_f32 v155, v242, v155
  v_mul_f32 v156, v242, v156
  v_mfma_f32_32x32x16_bf16 v[160:175], v[204:207], v[108:111], v[160:175]
  v_mul_f32 v157, v242, v157
  v_mul_f32 v158, v242, v158
  v_mul_f32 v159, v242, v159
  v_cvt_pk_bf16_f32 v48, v144, v145
  v_cvt_pk_bf16_f32 v49, v146, v147
  v_cvt_pk_bf16_f32 v50, v148, v149
  v_cvt_pk_bf16_f32 v51, v150, v151
  v_cvt_pk_bf16_f32 v52, v152, v153
  v_cvt_pk_bf16_f32 v53, v154, v155
  v_cvt_pk_bf16_f32 v54, v156, v157
  v_cvt_pk_bf16_f32 v55, v158, v159
  ds_write_b128 v236, v[48:51] offset:4096
  ds_write_b128 v236, v[52:55] offset:5120
  s_mov_b64 exec, s[88:89]
  s_add_u32 s71, s80, 14336
  buffer_store_dwordx4 v[48:51], v237, s[20:23], s71 offen sc1
  s_add_u32 s71, s80, 17920
  buffer_store_dwordx4 v[52:55], v237, s[20:23], s71 offen sc1
  s_mov_b64 exec, -1
  v_mul_f32 v160, v242, v160
  v_mul_f32 v161, v242, v161
  v_mul_f32 v162, v242, v162
  v_mul_f32 v163, v242, v163
  v_mul_f32 v164, v242, v164
  v_mul_f32 v165, v242, v165
  v_mul_f32 v166, v242, v166
  v_mul_f32 v167, v242, v167
  v_mul_f32 v168, v242, v168
  v_mul_f32 v169, v242, v169
  v_mul_f32 v170, v242, v170
  v_mul_f32 v171, v242, v171
  v_mul_f32 v172, v242, v172
  v_mul_f32 v173, v242, v173
  v_mul_f32 v174, v242, v174
  v_mul_f32 v175, v242, v175
  v_cvt_pk_bf16_f32 v56, v160, v161
  v_cvt_pk_bf16_f32 v57, v162, v163
  v_cvt_pk_bf16_f32 v58, v164, v165
  v_cvt_pk_bf16_f32 v59, v166, v167
  v_cvt_pk_bf16_f32 v60, v168, v169
  v_cvt_pk_bf16_f32 v61, v170, v171
  v_cvt_pk_bf16_f32 v62, v172, v173
  v_cvt_pk_bf16_f32 v63, v174, v175
  ds_write_b128 v236, v[56:59] offset:6144
  ds_write_b128 v236, v[60:63] offset:7168
  s_mov_b64 exec, s[88:89]
  s_add_u32 s71, s80, 21504
  buffer_store_dwordx4 v[56:59], v237, s[20:23], s71 offen sc1
  s_add_u32 s71, s80, 25088
  buffer_store_dwordx4 v[60:63], v237, s[20:23], s71 offen sc1
  s_mov_b64 exec, -1
  s_waitcnt lgkmcnt(0)
  v_mbcnt_lo_u32_b32 v1, -1, 0
  v_mbcnt_hi_u32_b32 v1, -1, v1
  v_lshrrev_b32 v2, 4, v1
  v_and_b32 v3, 15, v1
  v_lshlrev_b32 v7, 2, v2
  v_xor_b32 v7, v3, v7
  v_lshlrev_b32 v7, 4, v7
  v_lshlrev_b32 v4, 10, v2
  v_add_u32 v4, v4, v7
  v_add_u32 v5, s67, v1
  v_add_u32 v5, 1, v5
  v_and_b32 v5, 3, v5
  v_add_u32 v5, s85, v5
  v_lshlrev_b32 v5, 7, v5
  s_lshl_b32 s70, s65, 20
  s_lshl_b32 s71, s63, 14
  s_add_u32 s70, s70, s71
  s_lshl_b32 s71, s67, 8
  s_add_u32 s46, s70, s71
  s_mul_i32 s47, s66, 11
  s_lshr_b32 s47, s47, 5
  s_mul_i32 s47, s47, 3
  s_sub_u32 s47, s66, s47
  s_add_u32 s70, s47, 0
  s_sub_u32 s71, s70, 3
  s_cmp_ge_u32 s70, 3
  s_cselect_b32 s70, s71, s70
  s_add_u32 s70, s70, s67
  s_add_u32 s70, s70, 1
  s_and_b32 s70, s70, 3
  s_lshl_b32 s71, s70, 18
  s_add_u32 s41, s46, s71
  s_add_u32 s70, s47, 1
  s_sub_u32 s71, s70, 3
  s_cmp_ge_u32 s70, 3
  s_cselect_b32 s70, s71, s70
  s_add_u32 s70, s70, s67
  s_add_u32 s70, s70, 1
  s_and_b32 s70, s70, 3
  s_lshl_b32 s71, s70, 18
  s_add_u32 s42, s46, s71
  s_add_u32 s70, s47, 2
  s_sub_u32 s71, s70, 3
  s_cmp_ge_u32 s70, 3
  s_cselect_b32 s70, s71, s70
  s_add_u32 s70, s70, s67
  s_add_u32 s70, s70, 1
  s_and_b32 s70, s70, 3
  s_lshl_b32 s71, s70, 18
  s_add_u32 s43, s46, s71
  s_lshl_b32 s71, s67, 18
  s_add_u32 s40, s46, s71
  s_and_b32 s70, s66, 1
  s_lshl_b32 s44, s70, 16
  s_sub_u32 s45, 65536, s44
  s_lshl_b32 s48, s63, 2
  s_add_u32 s48, s48, 33554432
  s_lshl_b32 s70, s86, 7
  s_add_u32 s70, s70, 33554432
  s_lshl_b32 s71, s63, 2
  s_add_u32 s70, s70, s71
  v_mov_b32 v244, 1
  s_waitcnt vmcnt(0)
  s_mov_b64 exec, 1
  buffer_store_dword v244, off, s[20:23], s70 sc1
  s_mov_b64 exec, -1
  s_barrier
  s_add_u32 m0, s81, 49152
  s_add_u32 s72, s40, s45
  s_add_u32 s71, s72, 131072
  buffer_load_dwordx4 v4, s[24:27], s71 offen offset:0 lds
  s_add_u32 s71, s72, 134144
  buffer_load_dwordx4 v4, s[24:27], s71 offen offset:1024 lds
  s_add_u32 s71, s72, 137216
  buffer_load_dwordx4 v4, s[24:27], s71 offen offset:2048 lds
  s_add_u32 s71, s72, 140288
  buffer_load_dwordx4 v4, s[24:27], s71 offen offset:3072 lds
  s_add_u32 m0, s81, 98304
  s_add_u32 s72, s41, s44
  s_add_u32 s71, s72, 131072
  buffer_load_dwordx4 v4, s[24:27], s71 offen offset:0 lds
  s_add_u32 s71, s72, 134144
  buffer_load_dwordx4 v4, s[24:27], s71 offen offset:1024 lds
  s_add_u32 s71, s72, 137216
  buffer_load_dwordx4 v4, s[24:27], s71 offen offset:2048 lds
  s_add_u32 s71, s72, 140288
  buffer_load_dwordx4 v4, s[24:27], s71 offen offset:3072 lds
  s_add_u32 m0, s81, 114688
  s_add_u32 s72, s41, s45
  s_add_u32 s71, s72, 131072
  buffer_load_dwordx4 v4, s[24:27], s71 offen offset:0 lds
  s_add_u32 s71, s72, 134144
  buffer_load_dwordx4 v4, s[24:27], s71 offen offset:1024 lds
  s_add_u32 s71, s72, 137216
  buffer_load_dwordx4 v4, s[24:27], s71 offen offset:2048 lds
  s_add_u32 s71, s72, 140288
  buffer_load_dwordx4 v4, s[24:27], s71 offen offset:3072 lds
  s_barrier
  s_add_u32 m0, s81, 131072
  s_add_u32 s72, s42, s44
  s_add_u32 s71, s72, 131072
  buffer_load_dwordx4 v4, s[24:27], s71 offen offset:0 lds
  s_add_u32 s71, s72, 134144
  buffer_load_dwordx4 v4, s[24:27], s71 offen offset:1024 lds
  s_add_u32 s71, s72, 137216
  buffer_load_dwordx4 v4, s[24:27], s71 offen offset:2048 lds
  s_add_u32 s71, s72, 140288
  buffer_load_dwordx4 v4, s[24:27], s71 offen offset:3072 lds
  s_add_u32 m0, s81, 147456
  s_add_u32 s72, s42, s45
  s_add_u32 s71, s72, 131072
  buffer_load_dwordx4 v4, s[24:27], s71 offen offset:0 lds
  s_add_u32 s71, s72, 134144
  buffer_load_dwordx4 v4, s[24:27], s71 offen offset:1024 lds
  s_add_u32 s71, s72, 137216
  buffer_load_dwordx4 v4, s[24:27], s71 offen offset:2048 lds
  s_add_u32 s71, s72, 140288
  buffer_load_dwordx4 v4, s[24:27], s71 offen offset:3072 lds
  s_waitcnt vmcnt(16)
  s_barrier
  s_add_u32 m0, s81, 32768
  s_add_u32 s72, s43, s44
  s_add_u32 s71, s72, 131072
  buffer_load_dwordx4 v4, s[24:27], s71 offen offset:0 lds
  s_add_u32 s71, s72, 134144
  buffer_load_dwordx4 v4, s[24:27], s71 offen offset:1024 lds
  s_add_u32 s71, s72, 137216
  buffer_load_dwordx4 v4, s[24:27], s71 offen offset:2048 lds
  s_add_u32 s71, s72, 140288
  buffer_load_dwordx4 v4, s[24:27], s71 offen offset:3072 lds
  s_add_u32 m0, s81, 65536
  s_add_u32 s72, s43, s45
  s_add_u32 s71, s72, 131072
  buffer_load_dwordx4 v4, s[24:27], s71 offen offset:0 lds
  s_add_u32 s71, s72, 134144
  buffer_load_dwordx4 v4, s[24:27], s71 offen offset:1024 lds
  s_add_u32 s71, s72, 137216
  buffer_load_dwordx4 v4, s[24:27], s71 offen offset:2048 lds
  s_add_u32 s71, s72, 140288
  buffer_load_dwordx4 v4, s[24:27], s71 offen offset:3072 lds
  s_waitcnt vmcnt(0)
  s_barrier
  s_endpgm
A_tope:
  s_cmp_eq_u32 s77, 0
  s_cbranch_scc0 A_top8
  s_waitcnt vmcnt(8)
  s_barrier
  ds_read_b128 v[0:3], v236 offset:0
  ds_read_b128 v[4:7], v236 offset:1024
  ds_read_b128 v[8:11], v236 offset:2048
  ds_read_b128 v[12:15], v236 offset:3072
  ds_read_b128 v[16:19], v236 offset:4096
  ds_read_b128 v[20:23], v236 offset:5120
  ds_read_b128 v[24:27], v236 offset:6144
  ds_read_b128 v[28:31], v236 offset:7168
  ds_read_b128 v[176:179], v224 offset:0
  ds_read_b128 v[180:183], v225 offset:0
  ds_read_b128 v[184:187], v226 offset:0
  ds_read_b128 v[188:191], v227 offset:0
  ds_read_b128 v[192:195], v228 offset:0
  ds_read_b128 v[196:199], v229 offset:0
  ds_read_b128 v[200:203], v230 offset:0
  v_add_u32 v236, 16384, v236
  v_mov_b64 v[112:113], 0
  v_mov_b64 v[114:115], 0
  v_mov_b64 v[116:117], 0
  v_mov_b64 v[118:119], 0
  v_mov_b64 v[120:121], 0
  v_mov_b64 v[122:123], 0
  v_mov_b64 v[124:125], 0
  v_mov_b64 v[126:127], 0
  s_waitcnt lgkmcnt(5)
  ds_read_b128 v[204:207], v231 offset:0
  v_mfma_f32_32x32x16_bf16 v[32:47], v[176:179], v[0:3], v[208:223]
  ds_read_b128 v[176:179], v224 offset:8192
  v_mov_b64 v[128:129], 0
  v_mov_b64 v[130:131], 0
  v_mov_b64 v[132:133], 0
  v_mfma_f32_32x32x16_bf16 v[32:47], v[180:183], v[4:7], v[32:47]
  ds_read_b128 v[180:183], v225 offset:8192
  v_mov_b64 v[134:135], 0
  v_mov_b64 v[136:137], 0
  v_mov_b64 v[138:139], 0
  s_waitcnt lgkmcnt(6)
  v_mfma_f32_32x32x16_bf16 v[32:47], v[184:187], v[8:11], v[32:47]
  ds_read_b128 v[184:187], v226 offset:8192
  v_mov_b64 v[140:141], 0
  v_mov_b64 v[142:143], 0
  v_mfma_f32_32x32x16_bf16 v[32:47], v[188:191], v[12:15], v[32:47]
  ds_read_b128 v[188:191], v227 offset:8192
  v_mov_b64 v[144:145], 0
  v_mov_b64 v[146:147], 0
  v_mov_b64 v[148:149], 0
  s_waitcnt lgkmcnt(6)
  v_mfma_f32_32x32x16_bf16 v[32:47], v[192:195], v[16:19], v[32:47]
  ds_read_b128 v[192:195], v228 offset:8192
  v_mov_b64 v[150:151], 0
  v_mov_b64 v[152:153], 0
  v_mov_b64 v[154:155], 0
  v_mfma_f32_32x32x16_bf16 v[32:47], v[196:199], v[20:23], v[32:47]
  ds_read_b128 v[196:199], v229 offset:8192
  v_mov_b64 v[156:157], 0
  v_mov_b64 v[158:159], 0
  s_waitcnt lgkmcnt(6)
  v_mfma_f32_32x32x16_bf16 v[32:47], v[200:203], v[24:27], v[32:47]
  ds_read_b128 v[200:203], v230 offset:8192
  v_mov_b64 v[160:161], 0
  v_mov_b64 v[162:163], 0
  v_mov_b64 v[164:165], 0
  v_mfma_f32_32x32x16_bf16 v[32:47], v[204:207], v[28:31], v[32:47]
  ds_read_b128 v[204:207], v231 offset:8192
  v_mov_b64 v[166:167], 0
  v_mov_b64 v[168:169], 0
  v_mov_b64 v[170:171], 0
  s_waitcnt lgkmcnt(6)
  v_mfma_f32_32x32x16_bf16 v[48:63], v[176:179], v[0:3], v[208:223]
  v_mov_b64 v[172:173], 0
  v_mov_b64 v[174:175], 0
  v_mfma_f32_32x32x16_bf16 v[48:63], v[180:183], v[4:7], v[48:63]
  s_waitcnt lgkmcnt(4)
  v_mfma_f32_32x32x16_bf16 v[48:63], v[184:187], v[8:11], v[48:63]
  s_nop 0
  v_max3_f32 v248, v32, v33, v34
  v_max3_f32 v249, v40, v41, v42
  v_mfma_f32_32x32x16_bf16 v[48:63], v[188:191], v[12:15], v[48:63]
  v_max3_f32 v248, v248, v35, v36
  s_waitcnt lgkmcnt(2)
  v_mfma_f32_32x32x16_bf16 v[48:63], v[192:195], v[16:19], v[48:63]
  v_max3_f32 v249, v249, v43, v44
  v_mfma_f32_32x32x16_bf16 v[48:63], v[196:199], v[20:23], v[48:63]
  v_max3_f32 v248, v248, v37, v38
  s_waitcnt lgkmcnt(0)
  v_mfma_f32_32x32x16_bf16 v[48:63], v[200:203], v[24:27], v[48:63]
  v_max3_f32 v249, v249, v45, v46
  v_mfma_f32_32x32x16_bf16 v[48:63], v[204:207], v[28:31], v[48:63]
  v_max3_f32 v248, v248, v39, v47
  s_bitcmp1_b32 s76, s77
  s_cselect_b32 s70, s79, s3
  v_add_u32 v224, s70, v224
  v_add_u32 v225, s70, v225
  v_add_u32 v226, s70, v226
  v_add_u32 v227, s70, v227
  v_add_u32 v228, s70, v228
  v_add_u32 v229, s70, v229
  v_add_u32 v230, s70, v230
  v_add_u32 v231, s70, v231
  v_add_u32 v232, s70, v232
  v_add_u32 v233, s70, v233
  v_add_u32 v234, s70, v234
  v_add_u32 v235, s70, v235
  v_max3_f32 v250, v48, v49, v50
  v_max3_f32 v251, v56, v57, v58
  v_max3_f32 v250, v250, v51, v52
  v_max3_f32 v251, v251, v59, v60
  v_max3_f32 v250, v250, v53, v54
  v_max3_f32 v251, v251, v61, v62
  v_max3_f32 v250, v250, v55, v63
  v_max3_f32 v248, v248, v249, v250
  v_max_f32 v248, v248, v251
  v_mov_b32 v249, v248
  s_nop 1
  v_permlane32_swap_b32 v248, v249
  v_max_f32 v248, v248, v249
  v_sub_f32 v32, v32, v248
  v_sub_f32 v33, v33, v248
  v_sub_f32 v34, v34, v248
  v_sub_f32 v35, v35, v248
  v_sub_f32 v36, v36, v248
  v_sub_f32 v37, v37, v248
  v_sub_f32 v38, v38, v248
  v_sub_f32 v39, v39, v248
  v_sub_f32 v40, v40, v248
  v_sub_f32 v41, v41, v248
  v_sub_f32 v42, v42, v248
  v_sub_f32 v43, v43, v248
  v_sub_f32 v44, v44, v248
  v_sub_f32 v45, v45, v248
  v_sub_f32 v46, v46, v248
  v_sub_f32 v47, v47, v248
  v_exp_f32 v32, v32
  v_sub_f32 v48, v48, v248
  v_sub_f32 v208, v208, v248
  v_exp_f32 v33, v33
  v_sub_f32 v49, v49, v248
  v_sub_f32 v209, v209, v248
  v_exp_f32 v34, v34
  v_sub_f32 v50, v50, v248
  v_sub_f32 v210, v210, v248
  v_exp_f32 v35, v35
  v_sub_f32 v51, v51, v248
  v_sub_f32 v211, v211, v248
  v_exp_f32 v36, v36
  v_sub_f32 v52, v52, v248
  v_sub_f32 v212, v212, v248
  v_exp_f32 v37, v37
  v_sub_f32 v53, v53, v248
  v_sub_f32 v213, v213, v248
  v_exp_f32 v38, v38
  v_sub_f32 v54, v54, v248
  v_sub_f32 v214, v214, v248
  v_exp_f32 v39, v39
  v_sub_f32 v55, v55, v248
  v_sub_f32 v215, v215, v248
  v_exp_f32 v40, v40
  v_sub_f32 v56, v56, v248
  v_sub_f32 v216, v216, v248
  v_exp_f32 v41, v41
  v_sub_f32 v57, v57, v248
  v_sub_f32 v217, v217, v248
  v_exp_f32 v42, v42
  v_sub_f32 v58, v58, v248
  v_sub_f32 v218, v218, v248
  v_exp_f32 v43, v43
  v_sub_f32 v59, v59, v248
  v_sub_f32 v219, v219, v248
  v_exp_f32 v44, v44
  v_sub_f32 v60, v60, v248
  v_sub_f32 v220, v220, v248
  v_exp_f32 v45, v45
  v_sub_f32 v61, v61, v248
  v_sub_f32 v221, v221, v248
  v_exp_f32 v46, v46
  v_sub_f32 v62, v62, v248
  v_sub_f32 v222, v222, v248
  v_exp_f32 v47, v47
  v_sub_f32 v63, v63, v248
  v_sub_f32 v223, v223, v248
  s_mov_b32 s77, 1
  s_branch A_par1
A_top8:
  s_barrier
  ds_read_b128 v[0:3], v236 offset:0
  ds_read_b128 v[4:7], v236 offset:1024
  ds_read_b128 v[8:11], v236 offset:2048
  ds_read_b128 v[12:15], v236 offset:3072
  ds_read_b128 v[16:19], v236 offset:4096
  ds_read_b128 v[20:23], v236 offset:5120
  ds_read_b128 v[24:27], v236 offset:6144
  ds_read_b128 v[28:31], v236 offset:7168
A_top8b:
  s_mov_b32 s75, 0xff800000
  s_waitcnt lgkmcnt(7)
  s_branch A_toper
A_topo:
  s_cmp_eq_u32 s77, 1
  s_cbranch_scc0 A_top7
  s_waitcnt vmcnt(0)
  s_barrier
  s_branch A_topor
A_top7:
  s_or_b32 s73, s73, 4
  s_barrier
  s_branch A_topor
A_resce:
  v_mov_b32 v249, v248
  s_nop 1
  v_permlane32_swap_b32 v248, v249
  v_max_f32 v248, v248, v249
  s_and_b32 s71, s77, 7
  s_cmp_eq_u32 s71, 0
  s_cbranch_scc1 A_hsw
  v_max_f32 v248, 0, v248
  v_sub_f32 v249, 0, v248
  v_exp_f32 v242, v249
  s_or_b32 s73, s73, 1
  v_mul_f32 v240, v242, v240
  v_mul_f32 v241, v242, v241
A_hswj:
  v_sub_f32 v32, v32, v248
  v_sub_f32 v33, v33, v248
  v_sub_f32 v34, v34, v248
  v_sub_f32 v35, v35, v248
  v_sub_f32 v36, v36, v248
  v_sub_f32 v37, v37, v248
  v_sub_f32 v38, v38, v248
  v_sub_f32 v39, v39, v248
  v_sub_f32 v40, v40, v248
  v_sub_f32 v41, v41, v248
  v_sub_f32 v42, v42, v248
  v_sub_f32 v43, v43, v248
  v_sub_f32 v44, v44, v248
  v_sub_f32 v45, v45, v248
  v_sub_f32 v46, v46, v248
  v_sub_f32 v47, v47, v248
  v_sub_f32 v48, v48, v248
  v_sub_f32 v49, v49, v248
  v_sub_f32 v50, v50, v248
  v_sub_f32 v51, v51, v248
  v_sub_f32 v52, v52, v248
  v_sub_f32 v53, v53, v248
  v_sub_f32 v54, v54, v248
  v_sub_f32 v55, v55, v248
  v_sub_f32 v56, v56, v248
  v_sub_f32 v57, v57, v248
  v_sub_f32 v58, v58, v248
  v_sub_f32 v59, v59, v248
  v_sub_f32 v60, v60, v248
  v_sub_f32 v61, v61, v248
  v_sub_f32 v62, v62, v248
  v_sub_f32 v63, v63, v248
  v_sub_f32 v208, v208, v248
  v_sub_f32 v209, v209, v248
  v_sub_f32 v210, v210, v248
  v_sub_f32 v211, v211, v248
  v_sub_f32 v212, v212, v248
  v_sub_f32 v213, v213, v248
  v_sub_f32 v214, v214, v248
  v_sub_f32 v215, v215, v248
  v_sub_f32 v216, v216, v248
  v_sub_f32 v217, v217, v248
  v_sub_f32 v218, v218, v248
  v_sub_f32 v219, v219, v248
  v_sub_f32 v220, v220, v248
  v_sub_f32 v221, v221, v248
  v_sub_f32 v222, v222, v248
  v_sub_f32 v223, v223, v248
  s_branch A_rescer
A_resco:
  v_mov_b32 v249, v248
  s_nop 1
  v_permlane32_swap_b32 v248, v249
  v_max_f32 v248, v248, v249
  v_max_f32 v248, 0, v248
  v_sub_f32 v249, 0, v248
  v_exp_f32 v242, v249
  s_or_b32 s73, s73, 1
  v_mul_f32 v240, v242, v240
  v_mul_f32 v241, v242, v241
  v_sub_f32 v64, v64, v248
  v_sub_f32 v65, v65, v248
  v_sub_f32 v66, v66, v248
  v_sub_f32 v67, v67, v248
  v_sub_f32 v68, v68, v248
  v_sub_f32 v69, v69, v248
  v_sub_f32 v70, v70, v248
  v_sub_f32 v71, v71, v248
  v_sub_f32 v72, v72, v248
  v_sub_f32 v73, v73, v248
  v_sub_f32 v74, v74, v248
  v_sub_f32 v75, v75, v248
  v_sub_f32 v76, v76, v248
  v_sub_f32 v77, v77, v248
  v_sub_f32 v78, v78, v248
  v_sub_f32 v79, v79, v248
  v_sub_f32 v80, v80, v248
  v_sub_f32 v81, v81, v248
  v_sub_f32 v82, v82, v248
  v_sub_f32 v83, v83, v248
  v_sub_f32 v84, v84, v248
  v_sub_f32 v85, v85, v248
  v_sub_f32 v86, v86, v248
  v_sub_f32 v87, v87, v248
  v_sub_f32 v88, v88, v248
  v_sub_f32 v89, v89, v248
  v_sub_f32 v90, v90, v248
  v_sub_f32 v91, v91, v248
  v_sub_f32 v92, v92, v248
  v_sub_f32 v93, v93, v248
  v_sub_f32 v94, v94, v248
  v_sub_f32 v95, v95, v248
  v_sub_f32 v208, v208, v248
  v_sub_f32 v209, v209, v248
  v_sub_f32 v210, v210, v248
  v_sub_f32 v211, v211, v248
  v_sub_f32 v212, v212, v248
  v_sub_f32 v213, v213, v248
  v_sub_f32 v214, v214, v248
  v_sub_f32 v215, v215, v248
  v_sub_f32 v216, v216, v248
  v_sub_f32 v217, v217, v248
  v_sub_f32 v218, v218, v248
  v_sub_f32 v219, v219, v248
  v_sub_f32 v220, v220, v248
  v_sub_f32 v221, v221, v248
  v_sub_f32 v222, v222, v248
  v_sub_f32 v223, v223, v248
  s_branch A_rescor
A_hsw:
  v_add_f32 v244, v240, v241
  v_mov_b32 v245, v244
  s_nop 1
  v_permlane32_swap_b32 v244, v245
  v_add_f32 v244, v244, v245
  v_rcp_f32 v238, v244
  v_mov_b64 v[240:241], 0
  s_mov_b32 s75, 0x41400000
  s_lshr_b32 s73, s77, 3
  s_add_u32 s73, s73, 2
  s_lshl_b32 s73, s73, 3
  s_branch A_hswj
A_pende:
  s_cmp_ge_u32 s73, 16
  s_cbranch_scc1 A_pz
  s_bitcmp1_b32 s73, 0
  s_cbranch_scc0 A_pne
  v_pk_mul_f32 v[112:113], v[112:113], v[242:243] op_sel_hi:[1,0]
  v_pk_mul_f32 v[114:115], v[114:115], v[242:243] op_sel_hi:[1,0]
  v_pk_mul_f32 v[116:117], v[116:117], v[242:243] op_sel_hi:[1,0]
  v_pk_mul_f32 v[118:119], v[118:119], v[242:243] op_sel_hi:[1,0]
  v_pk_mul_f32 v[120:121], v[120:121], v[242:243] op_sel_hi:[1,0]
  v_pk_mul_f32 v[122:123], v[122:123], v[242:243] op_sel_hi:[1,0]
  v_pk_mul_f32 v[124:125], v[124:125], v[242:243] op_sel_hi:[1,0]
  v_pk_mul_f32 v[126:127], v[126:127], v[242:243] op_sel_hi:[1,0]
  v_pk_mul_f32 v[128:129], v[128:129], v[242:243] op_sel_hi:[1,0]
  v_pk_mul_f32 v[130:131], v[130:131], v[242:243] op_sel_hi:[1,0]
  v_pk_mul_f32 v[132:133], v[132:133], v[242:243] op_sel_hi:[1,0]
  v_pk_mul_f32 v[134:135], v[134:135], v[242:243] op_sel_hi:[1,0]
  v_pk_mul_f32 v[136:137], v[136:137], v[242:243] op_sel_hi:[1,0]
  v_pk_mul_f32 v[138:139], v[138:139], v[242:243] op_sel_hi:[1,0]
  v_pk_mul_f32 v[140:141], v[140:141], v[242:243] op_sel_hi:[1,0]
  v_pk_mul_f32 v[142:143], v[142:143], v[242:243] op_sel_hi:[1,0]
  v_pk_mul_f32 v[144:145], v[144:145], v[242:243] op_sel_hi:[1,0]
  v_pk_mul_f32 v[146:147], v[146:147], v[242:243] op_sel_hi:[1,0]
  v_pk_mul_f32 v[148:149], v[148:149], v[242:243] op_sel_hi:[1,0]
  v_pk_mul_f32 v[150:151], v[150:151], v[242:243] op_sel_hi:[1,0]
  v_pk_mul_f32 v[152:153], v[152:153], v[242:243] op_sel_hi:[1,0]
  v_pk_mul_f32 v[154:155], v[154:155], v[242:243] op_sel_hi:[1,0]
  v_pk_mul_f32 v[156:157], v[156:157], v[242:243] op_sel_hi:[1,0]
  v_pk_mul_f32 v[158:159], v[158:159], v[242:243] op_sel_hi:[1,0]
  v_pk_mul_f32 v[160:161], v[160:161], v[242:243] op_sel_hi:[1,0]
  v_pk_mul_f32 v[162:163], v[162:163], v[242:243] op_sel_hi:[1,0]
  v_pk_mul_f32 v[164:165], v[164:165], v[242:243] op_sel_hi:[1,0]
  v_pk_mul_f32 v[166:167], v[166:167], v[242:243] op_sel_hi:[1,0]
  v_pk_mul_f32 v[168:169], v[168:169], v[242:243] op_sel_hi:[1,0]
  v_pk_mul_f32 v[170:171], v[170:171], v[242:243] op_sel_hi:[1,0]
  v_pk_mul_f32 v[172:173], v[172:173], v[242:243] op_sel_hi:[1,0]
  v_pk_mul_f32 v[174:175], v[174:175], v[242:243] op_sel_hi:[1,0]
A_pne:
  s_mov_b32 s73, 0
  s_branch A_pender
A_pendo:
  s_bitcmp1_b32 s73, 0
  s_cbranch_scc0 A_pno
  v_pk_mul_f32 v[112:113], v[112:113], v[242:243] op_sel_hi:[1,0]
  v_pk_mul_f32 v[114:115], v[114:115], v[242:243] op_sel_hi:[1,0]
  v_pk_mul_f32 v[116:117], v[116:117], v[242:243] op_sel_hi:[1,0]
  v_pk_mul_f32 v[118:119], v[118:119], v[242:243] op_sel_hi:[1,0]
  v_pk_mul_f32 v[120:121], v[120:121], v[242:243] op_sel_hi:[1,0]
  v_pk_mul_f32 v[122:123], v[122:123], v[242:243] op_sel_hi:[1,0]
  v_pk_mul_f32 v[124:125], v[124:125], v[242:243] op_sel_hi:[1,0]
  v_pk_mul_f32 v[126:127], v[126:127], v[242:243] op_sel_hi:[1,0]
  v_pk_mul_f32 v[128:129], v[128:129], v[242:243] op_sel_hi:[1,0]
  v_pk_mul_f32 v[130:131], v[130:131], v[242:243] op_sel_hi:[1,0]
  v_pk_mul_f32 v[132:133], v[132:133], v[242:243] op_sel_hi:[1,0]
  v_pk_mul_f32 v[134:135], v[134:135], v[242:243] op_sel_hi:[1,0]
  v_pk_mul_f32 v[136:137], v[136:137], v[242:243] op_sel_hi:[1,0]
  v_pk_mul_f32 v[138:139], v[138:139], v[242:243] op_sel_hi:[1,0]
  v_pk_mul_f32 v[140:141], v[140:141], v[242:243] op_sel_hi:[1,0]
  v_pk_mul_f32 v[142:143], v[142:143], v[242:243] op_sel_hi:[1,0]
  v_pk_mul_f32 v[144:145], v[144:145], v[242:243] op_sel_hi:[1,0]
  v_pk_mul_f32 v[146:147], v[146:147], v[242:243] op_sel_hi:[1,0]
  v_pk_mul_f32 v[148:149], v[148:149], v[242:243] op_sel_hi:[1,0]
  v_pk_mul_f32 v[150:151], v[150:151], v[242:243] op_sel_hi:[1,0]
  v_pk_mul_f32 v[152:153], v[152:153], v[242:243] op_sel_hi:[1,0]
  v_pk_mul_f32 v[154:155], v[154:155], v[242:243] op_sel_hi:[1,0]
  v_pk_mul_f32 v[156:157], v[156:157], v[242:243] op_sel_hi:[1,0]
  v_pk_mul_f32 v[158:159], v[158:159], v[242:243] op_sel_hi:[1,0]
  v_pk_mul_f32 v[160:161], v[160:161], v[242:243] op_sel_hi:[1,0]
  v_pk_mul_f32 v[162:163], v[162:163], v[242:243] op_sel_hi:[1,0]
  v_pk_mul_f32 v[164:165], v[164:165], v[242:243] op_sel_hi:[1,0]
  v_pk_mul_f32 v[166:167], v[166:167], v[242:243] op_sel_hi:[1,0]
  v_pk_mul_f32 v[168:169], v[168:169], v[242:243] op_sel_hi:[1,0]
  v_pk_mul_f32 v[170:171], v[170:171], v[242:243] op_sel_hi:[1,0]
  v_pk_mul_f32 v[172:173], v[172:173], v[242:243] op_sel_hi:[1,0]
  v_pk_mul_f32 v[174:175], v[174:175], v[242:243] op_sel_hi:[1,0]
A_pno:
  s_bitcmp1_b32 s73, 2
  s_cbranch_scc0 A_pmo
  v_mov_b64 v[208:209], 0
  v_mov_b64 v[210:211], 0
  v_mov_b64 v[212:213], 0
  v_mov_b64 v[214:215], 0
  v_mov_b64 v[216:217], 0
  v_mov_b64 v[218:219], 0
  v_mov_b64 v[220:221], 0
  v_mov_b64 v[222:223], 0
A_pmo:
  s_mov_b32 s73, 0
  s_branch A_pendor
A_pz:
  s_cmp_eq_u32 s73, 24
  s_cbranch_scc0 A_pz2
  v_pk_mul_f32 v[112:113], v[112:113], v[238:239] op_sel_hi:[1,0]
  v_pk_mul_f32 v[114:115], v[114:115], v[238:239] op_sel_hi:[1,0]
  v_pk_mul_f32 v[116:117], v[116:117], v[238:239] op_sel_hi:[1,0]
  v_pk_mul_f32 v[118:119], v[118:119], v[238:239] op_sel_hi:[1,0]
  v_pk_mul_f32 v[120:121], v[120:121], v[238:239] op_sel_hi:[1,0]
  v_pk_mul_f32 v[122:123], v[122:123], v[238:239] op_sel_hi:[1,0]
  v_pk_mul_f32 v[124:125], v[124:125], v[238:239] op_sel_hi:[1,0]
  v_pk_mul_f32 v[126:127], v[126:127], v[238:239] op_sel_hi:[1,0]
  v_cvt_pk_bf16_f32 v176, v112, v113
  v_cvt_pk_bf16_f32 v177, v114, v115
  v_cvt_pk_bf16_f32 v178, v116, v117
  v_cvt_pk_bf16_f32 v179, v118, v119
  ds_write_b128 v236, v[176:179] offset:0
  v_cvt_pk_bf16_f32 v180, v120, v121
  v_cvt_pk_bf16_f32 v181, v122, v123
  v_cvt_pk_bf16_f32 v182, v124, v125
  v_cvt_pk_bf16_f32 v183, v126, v127
  ds_write_b128 v236, v[180:183] offset:1024
  v_pk_mul_f32 v[128:129], v[128:129], v[238:239] op_sel_hi:[1,0]
  v_pk_mul_f32 v[130:131], v[130:131], v[238:239] op_sel_hi:[1,0]
  v_pk_mul_f32 v[132:133], v[132:133], v[238:239] op_sel_hi:[1,0]
  v_pk_mul_f32 v[134:135], v[134:135], v[238:239] op_sel_hi:[1,0]
  v_pk_mul_f32 v[136:137], v[136:137], v[238:239] op_sel_hi:[1,0]
  v_pk_mul_f32 v[138:139], v[138:139], v[238:239] op_sel_hi:[1,0]
  v_pk_mul_f32 v[140:141], v[140:141], v[238:239] op_sel_hi:[1,0]
  v_pk_mul_f32 v[142:143], v[142:143], v[238:239] op_sel_hi:[1,0]
  v_cvt_pk_bf16_f32 v184, v128, v129
  v_cvt_pk_bf16_f32 v185, v130, v131
  v_cvt_pk_bf16_f32 v186, v132, v133
  v_cvt_pk_bf16_f32 v187, v134, v135
  ds_write_b128 v236, v[184:187] offset:2048
  v_cvt_pk_bf16_f32 v188, v136, v137
  v_cvt_pk_bf16_f32 v189, v138, v139
  v_cvt_pk_bf16_f32 v190, v140, v141
  v_cvt_pk_bf16_f32 v191, v142, v143
  ds_write_b128 v236, v[188:191] offset:3072
  v_pk_mul_f32 v[144:145], v[144:145], v[238:239] op_sel_hi:[1,0]
  v_pk_mul_f32 v[146:147], v[146:147], v[238:239] op_sel_hi:[1,0]
  v_pk_mul_f32 v[148:149], v[148:149], v[238:239] op_sel_hi:[1,0]
  v_pk_mul_f32 v[150:151], v[150:151], v[238:239] op_sel_hi:[1,0]
  v_pk_mul_f32 v[152:153], v[152:153], v[238:239] op_sel_hi:[1,0]
  v_pk_mul_f32 v[154:155], v[154:155], v[238:239] op_sel_hi:[1,0]
  v_pk_mul_f32 v[156:157], v[156:157], v[238:239] op_sel_hi:[1,0]
  v_pk_mul_f32 v[158:159], v[158:159], v[238:239] op_sel_hi:[1,0]
  v_cvt_pk_bf16_f32 v192, v144, v145
  v_cvt_pk_bf16_f32 v193, v146, v147
  v_cvt_pk_bf16_f32 v194, v148, v149
  v_cvt_pk_bf16_f32 v195, v150, v151
  ds_write_b128 v236, v[192:195] offset:4096
  v_cvt_pk_bf16_f32 v196, v152, v153
  v_cvt_pk_bf16_f32 v197, v154, v155
  v_cvt_pk_bf16_f32 v198, v156, v157
  v_cvt_pk_bf16_f32 v199, v158, v159
  ds_write_b128 v236, v[196:199] offset:5120
  v_pk_mul_f32 v[160:161], v[160:161], v[238:239] op_sel_hi:[1,0]
  v_pk_mul_f32 v[162:163], v[162:163], v[238:239] op_sel_hi:[1,0]
  v_pk_mul_f32 v[164:165], v[164:165], v[238:239] op_sel_hi:[1,0]
  v_pk_mul_f32 v[166:167], v[166:167], v[238:239] op_sel_hi:[1,0]
  v_pk_mul_f32 v[168:169], v[168:169], v[238:239] op_sel_hi:[1,0]
  v_pk_mul_f32 v[170:171], v[170:171], v[238:239] op_sel_hi:[1,0]
  v_pk_mul_f32 v[172:173], v[172:173], v[238:239] op_sel_hi:[1,0]
  v_pk_mul_f32 v[174:175], v[174:175], v[238:239] op_sel_hi:[1,0]
  v_cvt_pk_bf16_f32 v200, v160, v161
  v_cvt_pk_bf16_f32 v201, v162, v163
  v_cvt_pk_bf16_f32 v202, v164, v165
  v_cvt_pk_bf16_f32 v203, v166, v167
  ds_write_b128 v236, v[200:203] offset:6144
  v_cvt_pk_bf16_f32 v204, v168, v169
  v_cvt_pk_bf16_f32 v205, v170, v171
  v_cvt_pk_bf16_f32 v206, v172, v173
  v_cvt_pk_bf16_f32 v207, v174, v175
  ds_write_b128 v236, v[204:207] offset:7168
  v_mov_b64 v[112:113], 0
  v_mov_b64 v[114:115], 0
  v_mov_b64 v[116:117], 0
  v_mov_b64 v[118:119], 0
  v_mov_b64 v[120:121], 0
  v_mov_b64 v[122:123], 0
  v_mov_b64 v[124:125], 0
  v_mov_b64 v[126:127], 0
  v_mov_b64 v[128:129], 0
  v_mov_b64 v[130:131], 0
  v_mov_b64 v[132:133], 0
  v_mov_b64 v[134:135], 0
  v_mov_b64 v[136:137], 0
  v_mov_b64 v[138:139], 0
  v_mov_b64 v[140:141], 0
  v_mov_b64 v[142:143], 0
  v_mov_b64 v[144:145], 0
  v_mov_b64 v[146:147], 0
  v_mov_b64 v[148:149], 0
  v_mov_b64 v[150:151], 0
  v_mov_b64 v[152:153], 0
  v_mov_b64 v[154:155], 0
  v_mov_b64 v[156:157], 0
  v_mov_b64 v[158:159], 0
  v_mov_b64 v[160:161], 0
  v_mov_b64 v[162:163], 0
  v_mov_b64 v[164:165], 0
  v_mov_b64 v[166:167], 0
  v_mov_b64 v[168:169], 0
  v_mov_b64 v[170:171], 0
  v_mov_b64 v[172:173], 0
  v_mov_b64 v[174:175], 0
  s_waitcnt lgkmcnt(0)
A_pz2:
  s_mov_b32 s73, 0
  s_branch A_pender
L_B:
  v_lshrrev_b32 v22, 2, v20
  v_and_b32 v23, 1, v19
  v_lshlrev_b32 v28, 13, v17
  v_lshlrev_b32 v29, 8, v22
  v_add_u32 v28, v28, v29
  v_lshlrev_b32 v29, 5, v23
  v_add_u32 v28, v28, v29
  v_and_b32 v29, 1, v18
  v_lshlrev_b32 v29, 4, v29
  v_add_u32 v28, v28, v29
  v_lshrrev_b32 v29, 1, v18
  v_lshlrev_b32 v29, 3, v29
  v_add_u32 v15, v28, v29
  v_add_u32 v28, 32768, v15
  v_xor_b32 v29, 0, v22
  v_lshlrev_b32 v29, 6, v29
  v_add_u32 v8, v28, v29
  v_xor_b32 v29, 1, v22
  v_lshlrev_b32 v29, 6, v29
  v_add_u32 v9, v28, v29
  v_xor_b32 v29, 2, v22
  v_lshlrev_b32 v29, 6, v29
  v_add_u32 v10, v28, v29
  v_xor_b32 v29, 3, v22
  v_lshlrev_b32 v29, 6, v29
  v_add_u32 v11, v28, v29
  v_and_b32 v28, 31, v1
  v_lshrrev_b32 v29, 1, v28
  v_and_b32 v29, 7, v29
  v_lshlrev_b32 v30, 2, v17
  v_xor_b32 v29, v29, v30
  v_lshlrev_b32 v28, 7, v28
  s_add_u32 s70, s81, 32768
  v_add_u32 v28, s70, v28
  v_xor_b32 v30, 0, v29
  v_lshlrev_b32 v30, 4, v30
  v_add_u32 v24, v28, v30
  v_xor_b32 v30, 1, v29
  v_lshlrev_b32 v30, 4, v30
  v_add_u32 v25, v28, v30
  v_xor_b32 v30, 2, v29
  v_lshlrev_b32 v30, 4, v30
  v_add_u32 v26, v28, v30
  v_xor_b32 v30, 3, v29
  v_lshlrev_b32 v30, 4, v30
  v_add_u32 v27, v28, v30
  v_mov_b32 v3, v2
  s_lshl_b32 s70, s64, 3
  s_add_u32 s70, s70, s66
  s_lshl_b32 s71, s70, 5
  s_add_u32 s71, s71, s68
  s_mul_i32 s80, s71, 28672
  s_lshl_b32 s71, s70, 2
  s_add_u32 s71, s71, s65
  s_lshl_b32 s85, s71, 2
  s_add_u32 s86, s85, s67
  s_cmp_eq_u32 s63, 3
  s_cselect_b32 s88, 0xffff, -1
  s_mov_b32 s89, s88
  s_or_b32 s70, s63, s65
  s_or_b32 s70, s70, s67
  s_cmp_lg_u32 s70, 0
  s_cbranch_scc1 B_nclr
  v_mov_b64 v[28:29], 0
  v_mov_b64 v[30:31], 0
  v_lshlrev_b32 v23, 4, v1
  s_lshl_b32 s70, s85, 7
  s_add_u32 s70, s70, 33554432
  buffer_store_dwordx4 v[28:31], v23, s[20:23], s70 offen sc1
  buffer_store_dwordx4 v[28:31], v23, s[20:23], s70 offen offset:1024 sc1
  s_nop 1
B_nclr:
  v_lshlrev_b32 v22, 8, v19
  v_add_u32 v2, v22, v21
  v_add_u32 v23, 0, v19
  v_xor_b32 v23, v20, v23
  v_lshlrev_b32 v23, 4, v23
  v_add_u32 v4, v22, v23
  v_add_u32 v23, 4, v19
  v_xor_b32 v23, v20, v23
  v_lshlrev_b32 v23, 4, v23
  v_add_u32 v5, v22, v23
  v_add_u32 v23, 8, v19
  v_xor_b32 v23, v20, v23
  v_lshlrev_b32 v23, 4, v23
  v_add_u32 v6, v22, v23
  v_add_u32 v23, 12, v19
  v_xor_b32 v23, v20, v23
  v_lshlrev_b32 v23, 4, v23
  v_add_u32 v7, v22, v23
  v_lshlrev_b32 v23, 10, v19
  v_add_u32 v12, v23, v21
  v_lshrrev_b32 v22, 2, v20
  v_mul_u32_u24 v13, 448, v17
  v_and_b32 v29, 31, v1
  v_add_u32 v13, v13, v29
  s_lshl_b32 s70, s63, 5
  v_add_u32 v13, s70, v13
  v_lshlrev_b32 v13, 4, v13
  s_lshl_b32 s70, s63, 13
  s_add_u32 s70, s70, 98304
  v_lshlrev_b32 v14, 4, v1
  v_add_u32 v14, s70, v14
  v_lshlrev_b32 v30, 11, v17
  v_lshlrev_b32 v29, 4, v29
  v_add_u32 v30, v30, v29
  s_add_u32 s70, s70, 16384
  v_add_u32 v31, s70, v30
  v_mov_b32 v18, v31
  v_mov_b32 v17, v22
  v_add_u32 v16, 3584, v13
  s_lshl_b32 s70, s65, 20
  s_lshl_b32 s71, s63, 14
  s_add_u32 s70, s70, s71
  s_lshl_b32 s71, s67, 8
  s_add_u32 s84, s70, s71
  s_lshl_b32 s70, s64, 3
  s_add_u32 s70, s70, s66
  s_lshl_b32 s70, s70, 5
  s_lshl_b32 s71, s65, 3
  s_add_u32 s70, s70, s71
  s_mul_i32 s73, s70, 28672
  s_mul_i32 s76, s66, 11
  s_lshr_b32 s76, s76, 5
  s_mul_i32 s76, s76, 3
  s_sub_u32 s76, s66, s76
  s_add_u32 s70, s67, 0
  s_and_b32 s70, s70, 3
  s_lshl_b32 s71, s70, 18
  s_add_u32 s54, s84, s71
  s_mul_i32 s71, s70, 57344
  s_add_u32 s58, s73, s71
  s_add_u32 s70, s76, 0
  s_sub_u32 s71, s70, 3
  s_cmp_ge_u32 s70, 3
  s_cselect_b32 s70, s71, s70
  s_add_u32 s70, s70, s67
  s_add_u32 s70, s70, 1
  s_and_b32 s70, s70, 3
  s_lshl_b32 s71, s70, 18
  s_add_u32 s55, s84, s71
  s_mul_i32 s71, s70, 57344
  s_add_u32 s59, s73, s71
  s_add_u32 s70, s76, 1
  s_sub_u32 s71, s70, 3
  s_cmp_ge_u32 s70, 3
  s_cselect_b32 s70, s71, s70
  s_add_u32 s70, s70, s67
  s_add_u32 s70, s70, 1
  s_and_b32 s70, s70, 3
  s_lshl_b32 s71, s70, 18
  s_add_u32 s56, s84, s71
  s_mul_i32 s71, s70, 57344
  s_add_u32 s60, s73, s71
  s_add_u32 s70, s76, 2
  s_sub_u32 s71, s70, 3
  s_cmp_ge_u32 s70, 3
  s_cselect_b32 s70, s71, s70
  s_add_u32 s70, s70, s67
  s_add_u32 s70, s70, 1
  s_and_b32 s70, s70, 3
  s_lshl_b32 s71, s70, 18
  s_add_u32 s57, s84, s71
  s_mul_i32 s71, s70, 57344
  s_add_u32 s61, s73, s71
  s_and_b32 s70, s66, 1
  s_lshl_b32 s77, s70, 16
  s_sub_u32 s79, 65536, s77
  s_mul_i32 s76, s70, 14336
  s_sub_u32 s3, 14336, s76
  s_lshl_b32 s70, s70, 12
  s_sub_u32 s71, 4096, s70
  v_add_u32 v19, s71, v18
  v_add_u32 v18, s70, v18
  s_mov_b32 s74, 0x3e0293ee
  v_add_u32 v21, s67, v1
  v_add_u32 v21, 1, v21
  v_and_b32 v21, 3, v21
  v_add_u32 v21, s85, v21
  v_lshlrev_b32 v21, 7, v21
  v_add_u32 v22, s65, v1
  v_add_u32 v22, 1, v22
  v_and_b32 v22, 3, v22
  v_lshlrev_b32 v22, 2, v22
  s_and_b32 s71, s85, 0xfffffff0
  s_add_u32 s71, s71, s67
  v_add_u32 v22, s71, v22
  v_lshlrev_b32 v22, 7, v22
  v_lshlrev_b32 v23, 4, v1
  s_lshl_b32 s75, s65, 20
  s_lshr_b32 s70, s2, 3
  s_lshl_b32 s70, s70, 15
  s_add_u32 s75, s75, s70
  s_lshl_b32 s70, s63, 13
  s_add_u32 s75, s75, s70
  s_barrier
  ds_read_b128 v[64:67], v24 offset:0
  ds_read_b64_tr_b16 v[32:33], v8 offset:16384
  ds_read_b64_tr_b16 v[34:35], v8 offset:17408
  ds_read_b64_tr_b16 v[36:37], v9 offset:16384
  ds_read_b64_tr_b16 v[38:39], v9 offset:17408
  ds_read_b64_tr_b16 v[40:41], v10 offset:16384
  ds_read_b64_tr_b16 v[42:43], v10 offset:17408
  ds_read_b64_tr_b16 v[44:45], v11 offset:16384
  ds_read_b64_tr_b16 v[46:47], v11 offset:17408
  ds_read_b128 v[68:71], v25 offset:0
  ds_read_b64_tr_b16 v[48:49], v8 offset:18432
  ds_read_b64_tr_b16 v[50:51], v8 offset:19456
  s_waitcnt lgkmcnt(7)
  v_mfma_f32_32x32x16_bf16 v[192:207], v[32:35], v[64:67], 0
  ds_read_b64_tr_b16 v[52:53], v9 offset:18432
  ds_read_b64_tr_b16 v[54:55], v9 offset:19456
  v_mfma_f32_32x32x16_bf16 v[208:223], v[36:39], v[64:67], 0
  ds_read_b64_tr_b16 v[56:57], v10 offset:18432
  ds_read_b64_tr_b16 v[58:59], v10 offset:19456
  s_waitcnt lgkmcnt(7)
  v_mfma_f32_32x32x16_bf16 v[224:239], v[40:43], v[64:67], 0
  ds_read_b64_tr_b16 v[60:61], v11 offset:18432
  ds_read_b64_tr_b16 v[62:63], v11 offset:19456
  v_mfma_f32_32x32x16_bf16 v[240:255], v[44:47], v[64:67], 0
  ds_read_b128 v[72:75], v26 offset:0
  ds_read_b64_tr_b16 v[32:33], v8 offset:20480
  ds_read_b64_tr_b16 v[34:35], v8 offset:21504
  s_waitcnt lgkmcnt(7)
  v_mfma_f32_32x32x16_bf16 v[192:207], v[48:51], v[68:71], v[192:207]
  ds_read_b64_tr_b16 v[36:37], v9 offset:20480
  ds_read_b64_tr_b16 v[38:39], v9 offset:21504
  v_mfma_f32_32x32x16_bf16 v[208:223], v[52:55], v[68:71], v[208:223]
  ds_read_b64_tr_b16 v[40:41], v10 offset:20480
  ds_read_b64_tr_b16 v[42:43], v10 offset:21504
  s_waitcnt lgkmcnt(7)
  v_mfma_f32_32x32x16_bf16 v[224:239], v[56:59], v[68:71], v[224:239]
  ds_read_b64_tr_b16 v[44:45], v11 offset:20480
  ds_read_b64_tr_b16 v[46:47], v11 offset:21504
  v_mfma_f32_32x32x16_bf16 v[240:255], v[60:63], v[68:71], v[240:255]
  ds_read_b128 v[76:79], v27 offset:0
  ds_read_b64_tr_b16 v[48:49], v8 offset:22528
  ds_read_b64_tr_b16 v[50:51], v8 offset:23552
  s_waitcnt lgkmcnt(7)
  v_mfma_f32_32x32x16_bf16 v[192:207], v[32:35], v[72:75], v[192:207]
  ds_read_b64_tr_b16 v[52:53], v9 offset:22528
  ds_read_b64_tr_b16 v[54:55], v9 offset:23552
  v_mfma_f32_32x32x16_bf16 v[208:223], v[36:39], v[72:75], v[208:223]
  ds_read_b64_tr_b16 v[56:57], v10 offset:22528
  ds_read_b64_tr_b16 v[58:59], v10 offset:23552
  s_waitcnt lgkmcnt(7)
  v_mfma_f32_32x32x16_bf16 v[224:239], v[40:43], v[72:75], v[224:239]
  ds_read_b64_tr_b16 v[60:61], v11 offset:22528
  ds_read_b64_tr_b16 v[62:63], v11 offset:23552
  v_mfma_f32_32x32x16_bf16 v[240:255], v[44:47], v[72:75], v[240:255]
  s_barrier
  ds_read_b128 v[80:83], v24 offset:32768
  ds_read_b64_tr_b16 v[32:33], v8 offset:49152
  ds_read_b64_tr_b16 v[34:35], v8 offset:50176
  s_waitcnt lgkmcnt(7)
  v_mfma_f32_32x32x16_bf16 v[192:207], v[48:51], v[76:79], v[192:207]
  ds_read_b64_tr_b16 v[36:37], v9 offset:49152
  ds_read_b64_tr_b16 v[38:39], v9 offset:50176
  v_mfma_f32_32x32x16_bf16 v[208:223], v[52:55], v[76:79], v[208:223]
  ds_read_b64_tr_b16 v[40:41], v10 offset:49152
  ds_read_b64_tr_b16 v[42:43], v10 offset:50176
  s_waitcnt lgkmcnt(7)
  v_mfma_f32_32x32x16_bf16 v[224:239], v[56:59], v[76:79], v[224:239]
  ds_read_b64_tr_b16 v[44:45], v11 offset:49152
  ds_read_b64_tr_b16 v[46:47], v11 offset:50176
  v_mfma_f32_32x32x16_bf16 v[240:255], v[60:63], v[76:79], v[240:255]
  ds_read_b128 v[84:87], v25 offset:32768
  ds_read_b64_tr_b16 v[48:49], v8 offset:51200
  ds_read_b64_tr_b16 v[50:51], v8 offset:52224
  s_waitcnt lgkmcnt(7)
  v_mfma_f32_32x32x16_bf16 v[192:207], v[32:35], v[80:83], v[192:207]
  ds_read_b64_tr_b16 v[52:53], v9 offset:51200
  ds_read_b64_tr_b16 v[54:55], v9 offset:52224
  v_mfma_f32_32x32x16_bf16 v[208:223], v[36:39], v[80:83], v[208:223]
  ds_read_b64_tr_b16 v[56:57], v10 offset:51200
  ds_read_b64_tr_b16 v[58:59], v10 offset:52224
  s_waitcnt lgkmcnt(7)
  v_mfma_f32_32x32x16_bf16 v[224:239], v[40:43], v[80:83], v[224:239]
  ds_read_b64_tr_b16 v[60:61], v11 offset:51200
  ds_read_b64_tr_b16 v[62:63], v11 offset:52224
  v_mfma_f32_32x32x16_bf16 v[240:255], v[44:47], v[80:83], v[240:255]
  ds_read_b128 v[88:91], v26 offset:32768
  ds_read_b64_tr_b16 v[32:33], v8 offset:53248
  ds_read_b64_tr_b16 v[34:35], v8 offset:54272
  s_waitcnt lgkmcnt(7)
  v_mfma_f32_32x32x16_bf16 v[192:207], v[48:51], v[84:87], v[192:207]
  ds_read_b64_tr_b16 v[36:37], v9 offset:53248
  ds_read_b64_tr_b16 v[38:39], v9 offset:54272
  v_mfma_f32_32x32x16_bf16 v[208:223], v[52:55], v[84:87], v[208:223]
  ds_read_b64_tr_b16 v[40:41], v10 offset:53248
  ds_read_b64_tr_b16 v[42:43], v10 offset:54272
  s_waitcnt lgkmcnt(7)
  v_mfma_f32_32x32x16_bf16 v[224:239], v[56:59], v[84:87], v[224:239]
  ds_read_b64_tr_b16 v[44:45], v11 offset:53248
  ds_read_b64_tr_b16 v[46:47], v11 offset:54272
  v_mfma_f32_32x32x16_bf16 v[240:255], v[60:63], v[84:87], v[240:255]
  ds_read_b128 v[92:95], v27 offset:32768
  ds_read_b64_tr_b16 v[48:49], v8 offset:55296
  ds_read_b64_tr_b16 v[50:51], v8 offset:56320
  s_waitcnt lgkmcnt(7)
  v_mfma_f32_32x32x16_bf16 v[192:207], v[32:35], v[88:91], v[192:207]
  ds_read_b64_tr_b16 v[52:53], v9 offset:55296
  ds_read_b64_tr_b16 v[54:55], v9 offset:56320
  v_mfma_f32_32x32x16_bf16 v[208:223], v[36:39], v[88:91], v[208:223]
  ds_read_b64_tr_b16 v[56:57], v10 offset:55296
  ds_read_b64_tr_b16 v[58:59], v10 offset:56320
  s_waitcnt lgkmcnt(7)
  v_mfma_f32_32x32x16_bf16 v[224:239], v[40:43], v[88:91], v[224:239]
  ds_read_b64_tr_b16 v[60:61], v11 offset:55296
  ds_read_b64_tr_b16 v[62:63], v11 offset:56320
  v_mfma_f32_32x32x16_bf16 v[240:255], v[44:47], v[88:91], v[240:255]
  s_barrier
  v_add_u32 v8, 0x10000, v8
  v_add_u32 v9, 0x10000, v9
  v_add_u32 v10, 0x10000, v10
  v_add_u32 v11, 0x10000, v11
  v_add_u32 v24, 0x10000, v24
  v_add_u32 v25, 0x10000, v25
  v_add_u32 v26, 0x10000, v26
  v_add_u32 v27, 0x10000, v27
  ds_read_b128 v[96:99], v24 offset:0
  ds_read_b64_tr_b16 v[32:33], v8 offset:16384
  ds_read_b64_tr_b16 v[34:35], v8 offset:17408
  s_waitcnt lgkmcnt(7)
  v_mfma_f32_32x32x16_bf16 v[192:207], v[48:51], v[92:95], v[192:207]
  ds_read_b64_tr_b16 v[36:37], v9 offset:16384
  ds_read_b64_tr_b16 v[38:39], v9 offset:17408
  v_mfma_f32_32x32x16_bf16 v[208:223], v[52:55], v[92:95], v[208:223]
  ds_read_b64_tr_b16 v[40:41], v10 offset:16384
  ds_read_b64_tr_b16 v[42:43], v10 offset:17408
  s_waitcnt lgkmcnt(7)
  v_mfma_f32_32x32x16_bf16 v[224:239], v[56:59], v[92:95], v[224:239]
  ds_read_b64_tr_b16 v[44:45], v11 offset:16384
  ds_read_b64_tr_b16 v[46:47], v11 offset:17408
  v_mfma_f32_32x32x16_bf16 v[240:255], v[60:63], v[92:95], v[240:255]
  ds_read_b128 v[100:103], v25 offset:0
  ds_read_b64_tr_b16 v[48:49], v8 offset:18432
  ds_read_b64_tr_b16 v[50:51], v8 offset:19456
  s_waitcnt lgkmcnt(7)
  v_mfma_f32_32x32x16_bf16 v[192:207], v[32:35], v[96:99], v[192:207]
  ds_read_b64_tr_b16 v[52:53], v9 offset:18432
  ds_read_b64_tr_b16 v[54:55], v9 offset:19456
  v_mfma_f32_32x32x16_bf16 v[208:223], v[36:39], v[96:99], v[208:223]
  ds_read_b64_tr_b16 v[56:57], v10 offset:18432
  ds_read_b64_tr_b16 v[58:59], v10 offset:19456
  s_waitcnt lgkmcnt(7)
  v_mfma_f32_32x32x16_bf16 v[224:239], v[40:43], v[96:99], v[224:239]
  ds_read_b64_tr_b16 v[60:61], v11 offset:18432
  ds_read_b64_tr_b16 v[62:63], v11 offset:19456
  v_mfma_f32_32x32x16_bf16 v[240:255], v[44:47], v[96:99], v[240:255]
  ds_read_b128 v[104:107], v26 offset:0
  ds_read_b64_tr_b16 v[32:33], v8 offset:20480
  ds_read_b64_tr_b16 v[34:35], v8 offset:21504
  s_waitcnt lgkmcnt(7)
  v_mfma_f32_32x32x16_bf16 v[192:207], v[48:51], v[100:103], v[192:207]
  ds_read_b64_tr_b16 v[36:37], v9 offset:20480
  ds_read_b64_tr_b16 v[38:39], v9 offset:21504
  v_mfma_f32_32x32x16_bf16 v[208:223], v[52:55], v[100:103], v[208:223]
  ds_read_b64_tr_b16 v[40:41], v10 offset:20480
  ds_read_b64_tr_b16 v[42:43], v10 offset:21504
  s_waitcnt lgkmcnt(7)
  v_mfma_f32_32x32x16_bf16 v[224:239], v[56:59], v[100:103], v[224:239]
  ds_read_b64_tr_b16 v[44:45], v11 offset:20480
  ds_read_b64_tr_b16 v[46:47], v11 offset:21504
  v_mfma_f32_32x32x16_bf16 v[240:255], v[60:63], v[100:103], v[240:255]
  ds_read_b128 v[108:111], v27 offset:0
  ds_read_b64_tr_b16 v[48:49], v8 offset:22528
  ds_read_b64_tr_b16 v[50:51], v8 offset:23552
  s_waitcnt lgkmcnt(7)
  v_mfma_f32_32x32x16_bf16 v[192:207], v[32:35], v[104:107], v[192:207]
  ds_read_b64_tr_b16 v[52:53], v9 offset:22528
  ds_read_b64_tr_b16 v[54:55], v9 offset:23552
  v_mfma_f32_32x32x16_bf16 v[208:223], v[36:39], v[104:107], v[208:223]
  ds_read_b64_tr_b16 v[56:57], v10 offset:22528
  ds_read_b64_tr_b16 v[58:59], v10 offset:23552
  s_waitcnt lgkmcnt(7)
  v_mfma_f32_32x32x16_bf16 v[224:239], v[40:43], v[104:107], v[224:239]
  ds_read_b64_tr_b16 v[60:61], v11 offset:22528
  ds_read_b64_tr_b16 v[62:63], v11 offset:23552
  v_mfma_f32_32x32x16_bf16 v[240:255], v[44:47], v[104:107], v[240:255]
  s_barrier
  ds_read_b128 v[112:115], v24 offset:32768
  ds_read_b64_tr_b16 v[32:33], v8 offset:49152
  ds_read_b64_tr_b16 v[34:35], v8 offset:50176
  s_waitcnt lgkmcnt(7)
  v_mfma_f32_32x32x16_bf16 v[192:207], v[48:51], v[108:111], v[192:207]
  ds_read_b64_tr_b16 v[36:37], v9 offset:49152
  ds_read_b64_tr_b16 v[38:39], v9 offset:50176
  v_mfma_f32_32x32x16_bf16 v[208:223], v[52:55], v[108:111], v[208:223]
  ds_read_b64_tr_b16 v[40:41], v10 offset:49152
  ds_read_b64_tr_b16 v[42:43], v10 offset:50176
  s_waitcnt lgkmcnt(7)
  v_mfma_f32_32x32x16_bf16 v[224:239], v[56:59], v[108:111], v[224:239]
  ds_read_b64_tr_b16 v[44:45], v11 offset:49152
  ds_read_b64_tr_b16 v[46:47], v11 offset:50176
  v_mfma_f32_32x32x16_bf16 v[240:255], v[60:63], v[108:111], v[240:255]
  ds_read_b128 v[116:119], v25 offset:32768
  ds_read_b64_tr_b16 v[48:49], v8 offset:51200
  ds_read_b64_tr_b16 v[50:51], v8 offset:52224
  s_waitcnt lgkmcnt(7)
  v_mfma_f32_32x32x16_bf16 v[192:207], v[32:35], v[112:115], v[192:207]
  ds_read_b64_tr_b16 v[52:53], v9 offset:51200
  ds_read_b64_tr_b16 v[54:55], v9 offset:52224
  v_mfma_f32_32x32x16_bf16 v[208:223], v[36:39], v[112:115], v[208:223]
  ds_read_b64_tr_b16 v[56:57], v10 offset:51200
  ds_read_b64_tr_b16 v[58:59], v10 offset:52224
  s_waitcnt lgkmcnt(7)
  v_mfma_f32_32x32x16_bf16 v[224:239], v[40:43], v[112:115], v[224:239]
  ds_read_b64_tr_b16 v[60:61], v11 offset:51200
  ds_read_b64_tr_b16 v[62:63], v11 offset:52224
  v_mfma_f32_32x32x16_bf16 v[240:255], v[44:47], v[112:115], v[240:255]
  ds_read_b128 v[120:123], v26 offset:32768
  ds_read_b64_tr_b16 v[32:33], v8 offset:53248
  ds_read_b64_tr_b16 v[34:35], v8 offset:54272
  s_waitcnt lgkmcnt(7)
  v_mfma_f32_32x32x16_bf16 v[192:207], v[48:51], v[116:119], v[192:207]
  ds_read_b64_tr_b16 v[36:37], v9 offset:53248
  ds_read_b64_tr_b16 v[38:39], v9 offset:54272
  v_mfma_f32_32x32x16_bf16 v[208:223], v[52:55], v[116:119], v[208:223]
  ds_read_b64_tr_b16 v[40:41], v10 offset:53248
  ds_read_b64_tr_b16 v[42:43], v10 offset:54272
  s_waitcnt lgkmcnt(7)
  v_mfma_f32_32x32x16_bf16 v[224:239], v[56:59], v[116:119], v[224:239]
  ds_read_b64_tr_b16 v[44:45], v11 offset:53248
  ds_read_b64_tr_b16 v[46:47], v11 offset:54272
  v_mfma_f32_32x32x16_bf16 v[240:255], v[60:63], v[116:119], v[240:255]
  ds_read_b128 v[124:127], v27 offset:32768
  ds_read_b64_tr_b16 v[48:49], v8 offset:55296
  ds_read_b64_tr_b16 v[50:51], v8 offset:56320
  s_waitcnt lgkmcnt(7)
  v_mfma_f32_32x32x16_bf16 v[192:207], v[32:35], v[120:123], v[192:207]
  ds_read_b64_tr_b16 v[52:53], v9 offset:55296
  ds_read_b64_tr_b16 v[54:55], v9 offset:56320
  v_mfma_f32_32x32x16_bf16 v[208:223], v[36:39], v[120:123], v[208:223]
  ds_read_b64_tr_b16 v[56:57], v10 offset:55296
  ds_read_b64_tr_b16 v[58:59], v10 offset:56320
  s_waitcnt lgkmcnt(7)
  v_mfma_f32_32x32x16_bf16 v[224:239], v[40:43], v[120:123], v[224:239]
  ds_read_b64_tr_b16 v[60:61], v11 offset:55296
  ds_read_b64_tr_b16 v[62:63], v11 offset:56320
  v_mfma_f32_32x32x16_bf16 v[240:255], v[44:47], v[120:123], v[240:255]
  s_barrier
  v_add_u32 v8, 0xffff0000, v8
  v_add_u32 v9, 0xffff0000, v9
  v_add_u32 v10, 0xffff0000, v10
  v_add_u32 v11, 0xffff0000, v11
  v_add_u32 v24, 0xffff0000, v24
  v_add_u32 v25, 0xffff0000, v25
  v_add_u32 v26, 0xffff0000, v26
  v_add_u32 v27, 0xffff0000, v27
  ds_read_b128 v[128:131], v24 offset:0
  ds_read_b64_tr_b16 v[32:33], v8 offset:16384
  ds_read_b64_tr_b16 v[34:35], v8 offset:17408
  s_waitcnt lgkmcnt(7)
  v_mfma_f32_32x32x16_bf16 v[192:207], v[48:51], v[124:127], v[192:207]
  ds_read_b64_tr_b16 v[36:37], v9 offset:16384
  ds_read_b64_tr_b16 v[38:39], v9 offset:17408
  v_mfma_f32_32x32x16_bf16 v[208:223], v[52:55], v[124:127], v[208:223]
  ds_read_b64_tr_b16 v[40:41], v10 offset:16384
  ds_read_b64_tr_b16 v[42:43], v10 offset:17408
  s_waitcnt lgkmcnt(7)
  v_mfma_f32_32x32x16_bf16 v[224:239], v[56:59], v[124:127], v[224:239]
  ds_read_b64_tr_b16 v[44:45], v11 offset:16384
  ds_read_b64_tr_b16 v[46:47], v11 offset:17408
  v_mfma_f32_32x32x16_bf16 v[240:255], v[60:63], v[124:127], v[240:255]
  ds_read_b128 v[132:135], v25 offset:0
  ds_read_b64_tr_b16 v[48:49], v8 offset:18432
  ds_read_b64_tr_b16 v[50:51], v8 offset:19456
  s_waitcnt lgkmcnt(7)
  v_mfma_f32_32x32x16_bf16 v[192:207], v[32:35], v[128:131], v[192:207]
  ds_read_b64_tr_b16 v[52:53], v9 offset:18432
  ds_read_b64_tr_b16 v[54:55], v9 offset:19456
  v_mfma_f32_32x32x16_bf16 v[208:223], v[36:39], v[128:131], v[208:223]
  ds_read_b64_tr_b16 v[56:57], v10 offset:18432
  ds_read_b64_tr_b16 v[58:59], v10 offset:19456
  s_waitcnt lgkmcnt(7)
  v_mfma_f32_32x32x16_bf16 v[224:239], v[40:43], v[128:131], v[224:239]
  ds_read_b64_tr_b16 v[60:61], v11 offset:18432
  ds_read_b64_tr_b16 v[62:63], v11 offset:19456
  v_mfma_f32_32x32x16_bf16 v[240:255], v[44:47], v[128:131], v[240:255]
  ds_read_b128 v[136:139], v26 offset:0
  ds_read_b64_tr_b16 v[32:33], v8 offset:20480
  ds_read_b64_tr_b16 v[34:35], v8 offset:21504
  s_waitcnt lgkmcnt(7)
  v_mfma_f32_32x32x16_bf16 v[192:207], v[48:51], v[132:135], v[192:207]
  ds_read_b64_tr_b16 v[36:37], v9 offset:20480
  ds_read_b64_tr_b16 v[38:39], v9 offset:21504
  v_mfma_f32_32x32x16_bf16 v[208:223], v[52:55], v[132:135], v[208:223]
  ds_read_b64_tr_b16 v[40:41], v10 offset:20480
  ds_read_b64_tr_b16 v[42:43], v10 offset:21504
  s_waitcnt lgkmcnt(7)
  v_mfma_f32_32x32x16_bf16 v[224:239], v[56:59], v[132:135], v[224:239]
  ds_read_b64_tr_b16 v[44:45], v11 offset:20480
  ds_read_b64_tr_b16 v[46:47], v11 offset:21504
  v_mfma_f32_32x32x16_bf16 v[240:255], v[60:63], v[132:135], v[240:255]
  ds_read_b128 v[140:143], v27 offset:0
  ds_read_b64_tr_b16 v[48:49], v8 offset:22528
  ds_read_b64_tr_b16 v[50:51], v8 offset:23552
  s_waitcnt lgkmcnt(7)
  v_mfma_f32_32x32x16_bf16 v[192:207], v[32:35], v[136:139], v[192:207]
  ds_read_b64_tr_b16 v[52:53], v9 offset:22528
  ds_read_b64_tr_b16 v[54:55], v9 offset:23552
  v_mfma_f32_32x32x16_bf16 v[208:223], v[36:39], v[136:139], v[208:223]
  ds_read_b64_tr_b16 v[56:57], v10 offset:22528
  ds_read_b64_tr_b16 v[58:59], v10 offset:23552
  s_waitcnt lgkmcnt(7)
  v_mfma_f32_32x32x16_bf16 v[224:239], v[40:43], v[136:139], v[224:239]
  ds_read_b64_tr_b16 v[60:61], v11 offset:22528
  ds_read_b64_tr_b16 v[62:63], v11 offset:23552
  v_mfma_f32_32x32x16_bf16 v[240:255], v[44:47], v[136:139], v[240:255]
  s_barrier
  ds_read_b128 v[144:147], v24 offset:32768
  ds_read_b64_tr_b16 v[32:33], v8 offset:49152
  ds_read_b64_tr_b16 v[34:35], v8 offset:50176
  s_waitcnt lgkmcnt(7)
  v_mfma_f32_32x32x16_bf16 v[192:207], v[48:51], v[140:143], v[192:207]
  ds_read_b64_tr_b16 v[36:37], v9 offset:49152
  ds_read_b64_tr_b16 v[38:39], v9 offset:50176
  v_mfma_f32_32x32x16_bf16 v[208:223], v[52:55], v[140:143], v[208:223]
  ds_read_b64_tr_b16 v[40:41], v10 offset:49152
  ds_read_b64_tr_b16 v[42:43], v10 offset:50176
  s_waitcnt lgkmcnt(7)
  v_mfma_f32_32x32x16_bf16 v[224:239], v[56:59], v[140:143], v[224:239]
  ds_read_b64_tr_b16 v[44:45], v11 offset:49152
  ds_read_b64_tr_b16 v[46:47], v11 offset:50176
  v_mfma_f32_32x32x16_bf16 v[240:255], v[60:63], v[140:143], v[240:255]
  ds_read_b128 v[148:151], v25 offset:32768
  ds_read_b64_tr_b16 v[48:49], v8 offset:51200
  ds_read_b64_tr_b16 v[50:51], v8 offset:52224
  s_waitcnt lgkmcnt(7)
  v_mfma_f32_32x32x16_bf16 v[192:207], v[32:35], v[144:147], v[192:207]
  ds_read_b64_tr_b16 v[52:53], v9 offset:51200
  ds_read_b64_tr_b16 v[54:55], v9 offset:52224
  v_mfma_f32_32x32x16_bf16 v[208:223], v[36:39], v[144:147], v[208:223]
  ds_read_b64_tr_b16 v[56:57], v10 offset:51200
  ds_read_b64_tr_b16 v[58:59], v10 offset:52224
  s_waitcnt lgkmcnt(7)
  v_mfma_f32_32x32x16_bf16 v[224:239], v[40:43], v[144:147], v[224:239]
  ds_read_b64_tr_b16 v[60:61], v11 offset:51200
  ds_read_b64_tr_b16 v[62:63], v11 offset:52224
  v_mfma_f32_32x32x16_bf16 v[240:255], v[44:47], v[144:147], v[240:255]
  ds_read_b128 v[152:155], v26 offset:32768
  ds_read_b64_tr_b16 v[32:33], v8 offset:53248
  ds_read_b64_tr_b16 v[34:35], v8 offset:54272
  s_waitcnt lgkmcnt(7)
  v_mfma_f32_32x32x16_bf16 v[192:207], v[48:51], v[148:151], v[192:207]
  ds_read_b64_tr_b16 v[36:37], v9 offset:53248
  ds_read_b64_tr_b16 v[38:39], v9 offset:54272
  v_mfma_f32_32x32x16_bf16 v[208:223], v[52:55], v[148:151], v[208:223]
  ds_read_b64_tr_b16 v[40:41], v10 offset:53248
  ds_read_b64_tr_b16 v[42:43], v10 offset:54272
  s_waitcnt lgkmcnt(7)
  v_mfma_f32_32x32x16_bf16 v[224:239], v[56:59], v[148:151], v[224:239]
  ds_read_b64_tr_b16 v[44:45], v11 offset:53248
  ds_read_b64_tr_b16 v[46:47], v11 offset:54272
  v_mfma_f32_32x32x16_bf16 v[240:255], v[60:63], v[148:151], v[240:255]
  ds_read_b128 v[156:159], v27 offset:32768
  ds_read_b64_tr_b16 v[48:49], v8 offset:55296
  ds_read_b64_tr_b16 v[50:51], v8 offset:56320
  s_waitcnt lgkmcnt(7)
  v_mfma_f32_32x32x16_bf16 v[192:207], v[32:35], v[152:155], v[192:207]
  ds_read_b64_tr_b16 v[52:53], v9 offset:55296
  ds_read_b64_tr_b16 v[54:55], v9 offset:56320
  v_mfma_f32_32x32x16_bf16 v[208:223], v[36:39], v[152:155], v[208:223]
  ds_read_b64_tr_b16 v[56:57], v10 offset:55296
  ds_read_b64_tr_b16 v[58:59], v10 offset:56320
  s_waitcnt lgkmcnt(7)
  v_mfma_f32_32x32x16_bf16 v[224:239], v[40:43], v[152:155], v[224:239]
  ds_read_b64_tr_b16 v[60:61], v11 offset:55296
  ds_read_b64_tr_b16 v[62:63], v11 offset:56320
  v_mfma_f32_32x32x16_bf16 v[240:255], v[44:47], v[152:155], v[240:255]
  s_barrier
  v_add_u32 v8, 0x10000, v8
  v_add_u32 v9, 0x10000, v9
  v_add_u32 v10, 0x10000, v10
  v_add_u32 v11, 0x10000, v11
  v_add_u32 v24, 0x10000, v24
  v_add_u32 v25, 0x10000, v25
  v_add_u32 v26, 0x10000, v26
  v_add_u32 v27, 0x10000, v27
  ds_read_b128 v[160:163], v24 offset:0
  ds_read_b64_tr_b16 v[32:33], v8 offset:16384
  ds_read_b64_tr_b16 v[34:35], v8 offset:17408
  s_waitcnt lgkmcnt(7)
  v_mfma_f32_32x32x16_bf16 v[192:207], v[48:51], v[156:159], v[192:207]
  ds_read_b64_tr_b16 v[36:37], v9 offset:16384
  ds_read_b64_tr_b16 v[38:39], v9 offset:17408
  v_mfma_f32_32x32x16_bf16 v[208:223], v[52:55], v[156:159], v[208:223]
  ds_read_b64_tr_b16 v[40:41], v10 offset:16384
  ds_read_b64_tr_b16 v[42:43], v10 offset:17408
  s_waitcnt lgkmcnt(7)
  v_mfma_f32_32x32x16_bf16 v[224:239], v[56:59], v[156:159], v[224:239]
  ds_read_b64_tr_b16 v[44:45], v11 offset:16384
  ds_read_b64_tr_b16 v[46:47], v11 offset:17408
  v_mfma_f32_32x32x16_bf16 v[240:255], v[60:63], v[156:159], v[240:255]
  ds_read_b128 v[164:167], v25 offset:0
  ds_read_b64_tr_b16 v[48:49], v8 offset:18432
  ds_read_b64_tr_b16 v[50:51], v8 offset:19456
  s_waitcnt lgkmcnt(7)
  v_mfma_f32_32x32x16_bf16 v[192:207], v[32:35], v[160:163], v[192:207]
  ds_read_b64_tr_b16 v[52:53], v9 offset:18432
  ds_read_b64_tr_b16 v[54:55], v9 offset:19456
  v_mfma_f32_32x32x16_bf16 v[208:223], v[36:39], v[160:163], v[208:223]
  ds_read_b64_tr_b16 v[56:57], v10 offset:18432
  ds_read_b64_tr_b16 v[58:59], v10 offset:19456
  s_waitcnt lgkmcnt(7)
  v_mfma_f32_32x32x16_bf16 v[224:239], v[40:43], v[160:163], v[224:239]
  ds_read_b64_tr_b16 v[60:61], v11 offset:18432
  ds_read_b64_tr_b16 v[62:63], v11 offset:19456
  v_mfma_f32_32x32x16_bf16 v[240:255], v[44:47], v[160:163], v[240:255]
  ds_read_b128 v[168:171], v26 offset:0
  ds_read_b64_tr_b16 v[32:33], v8 offset:20480
  ds_read_b64_tr_b16 v[34:35], v8 offset:21504
  s_waitcnt lgkmcnt(7)
  v_mfma_f32_32x32x16_bf16 v[192:207], v[48:51], v[164:167], v[192:207]
  ds_read_b64_tr_b16 v[36:37], v9 offset:20480
  ds_read_b64_tr_b16 v[38:39], v9 offset:21504
  v_mfma_f32_32x32x16_bf16 v[208:223], v[52:55], v[164:167], v[208:223]
  ds_read_b64_tr_b16 v[40:41], v10 offset:20480
  ds_read_b64_tr_b16 v[42:43], v10 offset:21504
  s_waitcnt lgkmcnt(7)
  v_mfma_f32_32x32x16_bf16 v[224:239], v[56:59], v[164:167], v[224:239]
  ds_read_b64_tr_b16 v[44:45], v11 offset:20480
  ds_read_b64_tr_b16 v[46:47], v11 offset:21504
  v_mfma_f32_32x32x16_bf16 v[240:255], v[60:63], v[164:167], v[240:255]
  ds_read_b128 v[172:175], v27 offset:0
  ds_read_b64_tr_b16 v[48:49], v8 offset:22528
  ds_read_b64_tr_b16 v[50:51], v8 offset:23552
  s_waitcnt lgkmcnt(7)
  v_mfma_f32_32x32x16_bf16 v[192:207], v[32:35], v[168:171], v[192:207]
  ds_read_b64_tr_b16 v[52:53], v9 offset:22528
  ds_read_b64_tr_b16 v[54:55], v9 offset:23552
  v_mfma_f32_32x32x16_bf16 v[208:223], v[36:39], v[168:171], v[208:223]
  ds_read_b64_tr_b16 v[56:57], v10 offset:22528
  ds_read_b64_tr_b16 v[58:59], v10 offset:23552
  s_waitcnt lgkmcnt(7)
  v_mfma_f32_32x32x16_bf16 v[224:239], v[40:43], v[168:171], v[224:239]
  ds_read_b64_tr_b16 v[60:61], v11 offset:22528
  ds_read_b64_tr_b16 v[62:63], v11 offset:23552
  v_mfma_f32_32x32x16_bf16 v[240:255], v[44:47], v[168:171], v[240:255]
  s_barrier
  ds_read_b128 v[176:179], v24 offset:32768
  ds_read_b64_tr_b16 v[32:33], v8 offset:49152
  ds_read_b64_tr_b16 v[34:35], v8 offset:50176
  s_waitcnt lgkmcnt(7)
  v_mfma_f32_32x32x16_bf16 v[192:207], v[48:51], v[172:175], v[192:207]
  ds_read_b128 v[180:183], v25 offset:32768
  ds_read_b64_tr_b16 v[36:37], v8 offset:51200
  ds_read_b64_tr_b16 v[38:39], v8 offset:52224
  v_mfma_f32_32x32x16_bf16 v[208:223], v[52:55], v[172:175], v[208:223]
  ds_read_b128 v[184:187], v26 offset:32768
  ds_read_b64_tr_b16 v[40:41], v8 offset:53248
  ds_read_b64_tr_b16 v[42:43], v8 offset:54272
  s_waitcnt lgkmcnt(9)
  v_mfma_f32_32x32x16_bf16 v[224:239], v[56:59], v[172:175], v[224:239]
  ds_read_b128 v[188:191], v27 offset:32768
  ds_read_b64_tr_b16 v[44:45], v8 offset:55296
  ds_read_b64_tr_b16 v[46:47], v8 offset:56320
  v_mfma_f32_32x32x16_bf16 v[240:255], v[60:63], v[172:175], v[240:255]
  ds_read_b64_tr_b16 v[48:49], v9 offset:49152
  ds_read_b64_tr_b16 v[50:51], v9 offset:50176
  s_waitcnt lgkmcnt(8)
  v_mfma_f32_32x32x16_bf16 v[192:207], v[32:35], v[176:179], v[192:207]
  ds_read_b64_tr_b16 v[52:53], v9 offset:51200
  ds_read_b64_tr_b16 v[54:55], v9 offset:52224
  v_mfma_f32_32x32x16_bf16 v[192:207], v[36:39], v[180:183], v[192:207]
  ds_read_b64_tr_b16 v[56:57], v9 offset:53248
  ds_read_b64_tr_b16 v[58:59], v9 offset:54272
  s_waitcnt lgkmcnt(6)
  v_mfma_f32_32x32x16_bf16 v[192:207], v[40:43], v[184:187], v[192:207]
  ds_read_b64_tr_b16 v[60:61], v9 offset:55296
  ds_read_b64_tr_b16 v[62:63], v9 offset:56320
  v_mfma_f32_32x32x16_bf16 v[192:207], v[44:47], v[188:191], v[192:207]
  ds_read_b64_tr_b16 v[32:33], v10 offset:49152
  ds_read_b64_tr_b16 v[34:35], v10 offset:50176
  s_waitcnt lgkmcnt(6)
  v_mfma_f32_32x32x16_bf16 v[208:223], v[48:51], v[176:179], v[208:223]
  ds_read_b64_tr_b16 v[36:37], v10 offset:51200
  ds_read_b64_tr_b16 v[38:39], v10 offset:52224
  v_mfma_f32_32x32x16_bf16 v[208:223], v[52:55], v[180:183], v[208:223]
  ds_read_b64_tr_b16 v[40:41], v10 offset:53248
  ds_read_b64_tr_b16 v[42:43], v10 offset:54272
  s_nop 2
  v_pk_mul_f32 v[192:193], v[192:193], s[74:75] op_sel_hi:[1,0]
  v_pk_mul_f32 v[194:195], v[194:195], s[74:75] op_sel_hi:[1,0]
  v_pk_mul_f32 v[196:197], v[196:197], s[74:75] op_sel_hi:[1,0]
  v_pk_mul_f32 v[198:199], v[198:199], s[74:75] op_sel_hi:[1,0]
  v_pk_mul_f32 v[200:201], v[200:201], s[74:75] op_sel_hi:[1,0]
  s_waitcnt lgkmcnt(6)
  v_mfma_f32_32x32x16_bf16 v[208:223], v[56:59], v[184:187], v[208:223]
  ds_read_b64_tr_b16 v[44:45], v10 offset:55296
  ds_read_b64_tr_b16 v[46:47], v10 offset:56320
  v_pk_mul_f32 v[202:203], v[202:203], s[74:75] op_sel_hi:[1,0]
  v_pk_mul_f32 v[204:205], v[204:205], s[74:75] op_sel_hi:[1,0]
  v_pk_mul_f32 v[206:207], v[206:207], s[74:75] op_sel_hi:[1,0]
  v_cvt_pk_bf16_f32 v192, v192, v193
  v_mfma_f32_32x32x16_bf16 v[208:223], v[60:63], v[188:191], v[208:223]
  ds_read_b64_tr_b16 v[48:49], v11 offset:49152
  ds_read_b64_tr_b16 v[50:51], v11 offset:50176
  v_cvt_pk_bf16_f32 v193, v194, v195
  v_cvt_pk_bf16_f32 v194, v196, v197
  v_cvt_pk_bf16_f32 v195, v198, v199
  ds_write_b128 v14, v[192:195] offset:0
  v_cvt_pk_bf16_f32 v196, v200, v201
  s_waitcnt lgkmcnt(6)
  v_mfma_f32_32x32x16_bf16 v[224:239], v[32:35], v[176:179], v[224:239]
  ds_read_b64_tr_b16 v[52:53], v11 offset:51200
  ds_read_b64_tr_b16 v[54:55], v11 offset:52224
  v_cvt_pk_bf16_f32 v197, v202, v203
  v_cvt_pk_bf16_f32 v198, v204, v205
  v_cvt_pk_bf16_f32 v199, v206, v207
  ds_write_b128 v14, v[196:199] offset:1024
  v_mfma_f32_32x32x16_bf16 v[224:239], v[36:39], v[180:183], v[224:239]
  ds_read_b64_tr_b16 v[56:57], v11 offset:53248
  ds_read_b64_tr_b16 v[58:59], v11 offset:54272
  v_pk_mul_f32 v[208:209], v[208:209], s[74:75] op_sel_hi:[1,0]
  v_pk_mul_f32 v[210:211], v[210:211], s[74:75] op_sel_hi:[1,0]
  v_pk_mul_f32 v[212:213], v[212:213], s[74:75] op_sel_hi:[1,0]
  v_pk_mul_f32 v[214:215], v[214:215], s[74:75] op_sel_hi:[1,0]
  v_pk_mul_f32 v[216:217], v[216:217], s[74:75] op_sel_hi:[1,0]
  s_waitcnt lgkmcnt(6)
  v_mfma_f32_32x32x16_bf16 v[224:239], v[40:43], v[184:187], v[224:239]
  ds_read_b64_tr_b16 v[60:61], v11 offset:55296
  ds_read_b64_tr_b16 v[62:63], v11 offset:56320
  v_pk_mul_f32 v[218:219], v[218:219], s[74:75] op_sel_hi:[1,0]
  v_pk_mul_f32 v[220:221], v[220:221], s[74:75] op_sel_hi:[1,0]
  v_pk_mul_f32 v[222:223], v[222:223], s[74:75] op_sel_hi:[1,0]
  v_cvt_pk_bf16_f32 v208, v208, v209
  v_mfma_f32_32x32x16_bf16 v[224:239], v[44:47], v[188:191], v[224:239]
  v_cvt_pk_bf16_f32 v209, v210, v211
  v_cvt_pk_bf16_f32 v210, v212, v213
  v_cvt_pk_bf16_f32 v211, v214, v215
  ds_write_b128 v14, v[208:211] offset:2048
  v_cvt_pk_bf16_f32 v212, v216, v217
  s_waitcnt lgkmcnt(4)
  v_mfma_f32_32x32x16_bf16 v[240:255], v[48:51], v[176:179], v[240:255]
  v_cvt_pk_bf16_f32 v213, v218, v219
  v_cvt_pk_bf16_f32 v214, v220, v221
  v_cvt_pk_bf16_f32 v215, v222, v223
  ds_write_b128 v14, v[212:215] offset:3072
  v_mfma_f32_32x32x16_bf16 v[240:255], v[52:55], v[180:183], v[240:255]
  v_pk_mul_f32 v[224:225], v[224:225], s[74:75] op_sel_hi:[1,0]
  v_pk_mul_f32 v[226:227], v[226:227], s[74:75] op_sel_hi:[1,0]
  v_pk_mul_f32 v[228:229], v[228:229], s[74:75] op_sel_hi:[1,0]
  v_pk_mul_f32 v[230:231], v[230:231], s[74:75] op_sel_hi:[1,0]
  v_pk_mul_f32 v[232:233], v[232:233], s[74:75] op_sel_hi:[1,0]
  v_pk_mul_f32 v[234:235], v[234:235], s[74:75] op_sel_hi:[1,0]
  s_waitcnt lgkmcnt(0)
  v_mfma_f32_32x32x16_bf16 v[240:255], v[56:59], v[184:187], v[240:255]
  v_pk_mul_f32 v[236:237], v[236:237], s[74:75] op_sel_hi:[1,0]
  v_pk_mul_f32 v[238:239], v[238:239], s[74:75] op_sel_hi:[1,0]
  v_cvt_pk_bf16_f32 v224, v224, v225
  v_cvt_pk_bf16_f32 v225, v226, v227
  v_cvt_pk_bf16_f32 v226, v228, v229
  v_cvt_pk_bf16_f32 v227, v230, v231
  v_mfma_f32_32x32x16_bf16 v[240:255], v[60:63], v[188:191], v[240:255]
  ds_write_b128 v14, v[224:227] offset:4096
  v_cvt_pk_bf16_f32 v228, v232, v233
  v_cvt_pk_bf16_f32 v229, v234, v235
  v_cvt_pk_bf16_f32 v230, v236, v237
  v_cvt_pk_bf16_f32 v231, v238, v239
  ds_write_b128 v14, v[228:231] offset:5120
  s_nop 5
  v_pk_mul_f32 v[240:241], v[240:241], s[74:75] op_sel_hi:[1,0]
  v_pk_mul_f32 v[242:243], v[242:243], s[74:75] op_sel_hi:[1,0]
  v_pk_mul_f32 v[244:245], v[244:245], s[74:75] op_sel_hi:[1,0]
  v_pk_mul_f32 v[246:247], v[246:247], s[74:75] op_sel_hi:[1,0]
  v_pk_mul_f32 v[248:249], v[248:249], s[74:75] op_sel_hi:[1,0]
  v_pk_mul_f32 v[250:251], v[250:251], s[74:75] op_sel_hi:[1,0]
  v_pk_mul_f32 v[252:253], v[252:253], s[74:75] op_sel_hi:[1,0]
  v_pk_mul_f32 v[254:255], v[254:255], s[74:75] op_sel_hi:[1,0]
  v_cvt_pk_bf16_f32 v240, v240, v241
  v_cvt_pk_bf16_f32 v241, v242, v243
  v_cvt_pk_bf16_f32 v242, v244, v245
  v_cvt_pk_bf16_f32 v243, v246, v247
  ds_write_b128 v14, v[240:243] offset:6144
  v_cvt_pk_bf16_f32 v244, v248, v249
  v_cvt_pk_bf16_f32 v245, v250, v251
  v_cvt_pk_bf16_f32 v246, v252, v253
  v_cvt_pk_bf16_f32 v247, v254, v255
  ds_write_b128 v14, v[244:247] offset:7168
  s_waitcnt lgkmcnt(0)
  s_barrier
  v_add_u32 v8, 0xfffe8000, v8
  v_add_u32 v9, 0xfffe8000, v9
  v_add_u32 v10, 0xfffe8000, v10
  v_add_u32 v11, 0xfffe8000, v11
  ds_read_b64_tr_b16 v[32:33], v8 offset:16384
  ds_read_b64_tr_b16 v[34:35], v8 offset:17408
  ds_read_b64_tr_b16 v[36:37], v9 offset:16384
  ds_read_b64_tr_b16 v[38:39], v9 offset:17408
  ds_read_b64_tr_b16 v[40:41], v10 offset:16384
  ds_read_b64_tr_b16 v[42:43], v10 offset:17408
  ds_read_b64_tr_b16 v[44:45], v11 offset:16384
  ds_read_b64_tr_b16 v[46:47], v11 offset:17408
  ds_read_b64_tr_b16 v[48:49], v8 offset:18432
  ds_read_b64_tr_b16 v[50:51], v8 offset:19456
  ds_read_b64_tr_b16 v[52:53], v9 offset:18432
  ds_read_b64_tr_b16 v[54:55], v9 offset:19456
  s_waitcnt lgkmcnt(8)
  v_mfma_f32_32x32x16_bf16 v[192:207], v[32:35], v[64:67], 0
  ds_read_b64_tr_b16 v[56:57], v10 offset:18432
  ds_read_b64_tr_b16 v[58:59], v10 offset:19456
  s_add_u32 s72, s78, 1
  s_and_b32 s72, s72, 7
  s_lshl_b32 s72, s72, 19
  s_add_u32 s72, s72, s82
  s_add_u32 m0, s81, 131072
  s_add_u32 s71, s72, 256
  buffer_load_dwordx4 v3, s[12:15], s71 offen offset:0 lds
  v_mfma_f32_32x32x16_bf16 v[208:223], v[36:39], v[64:67], 0
  ds_read_b64_tr_b16 v[60:61], v11 offset:18432
  ds_read_b64_tr_b16 v[62:63], v11 offset:19456
  s_add_u32 s71, s72, 32000
  buffer_load_dwordx4 v3, s[12:15], s71 offen offset:1024 lds
  s_waitcnt lgkmcnt(8)
  v_mfma_f32_32x32x16_bf16 v[224:239], v[40:43], v[64:67], 0
  ds_read_b64_tr_b16 v[32:33], v8 offset:20480
  ds_read_b64_tr_b16 v[34:35], v8 offset:21504
  s_add_u32 s71, s72, 63744
  buffer_load_dwordx4 v3, s[12:15], s71 offen offset:2048 lds
  v_mfma_f32_32x32x16_bf16 v[240:255], v[44:47], v[64:67], 0
  ds_read_b64_tr_b16 v[36:37], v9 offset:20480
  ds_read_b64_tr_b16 v[38:39], v9 offset:21504
  s_add_u32 s71, s72, 95488
  buffer_load_dwordx4 v3, s[12:15], s71 offen offset:3072 lds
  s_waitcnt lgkmcnt(8)
  v_mfma_f32_32x32x16_bf16 v[192:207], v[48:51], v[68:71], v[192:207]
  ds_read_b64_tr_b16 v[40:41], v10 offset:20480
  ds_read_b64_tr_b16 v[42:43], v10 offset:21504
  s_add_u32 s72, s78, 2
  s_and_b32 s72, s72, 7
  s_lshl_b32 s72, s72, 19
  s_add_u32 s72, s72, s82
  s_add_u32 m0, s81, 147456
  s_add_u32 s71, s72, 256
  buffer_load_dwordx4 v3, s[12:15], s71 offen offset:0 lds
  v_mfma_f32_32x32x16_bf16 v[208:223], v[52:55], v[68:71], v[208:223]
  ds_read_b64_tr_b16 v[44:45], v11 offset:20480
  ds_read_b64_tr_b16 v[46:47], v11 offset:21504
  s_add_u32 s71, s72, 32000
  buffer_load_dwordx4 v3, s[12:15], s71 offen offset:1024 lds
  s_waitcnt lgkmcnt(8)
  v_mfma_f32_32x32x16_bf16 v[224:239], v[56:59], v[68:71], v[224:239]
  ds_read_b64_tr_b16 v[48:49], v8 offset:22528
  ds_read_b64_tr_b16 v[50:51], v8 offset:23552
  s_add_u32 s71, s72, 63744
  buffer_load_dwordx4 v3, s[12:15], s71 offen offset:2048 lds
  v_mfma_f32_32x32x16_bf16 v[240:255], v[60:63], v[68:71], v[240:255]
  ds_read_b64_tr_b16 v[52:53], v9 offset:22528
  ds_read_b64_tr_b16 v[54:55], v9 offset:23552
  s_add_u32 s71, s72, 95488
  buffer_load_dwordx4 v3, s[12:15], s71 offen offset:3072 lds
  s_waitcnt lgkmcnt(8)
  v_mfma_f32_32x32x16_bf16 v[192:207], v[32:35], v[72:75], v[192:207]
  ds_read_b64_tr_b16 v[56:57], v10 offset:22528
  ds_read_b64_tr_b16 v[58:59], v10 offset:23552
  s_add_u32 m0, s81, 65536
  s_add_u32 s70, s83, 32768
  buffer_load_dwordx4 v4, s[4:7], s70 offen offset:0 nt lds
  v_mfma_f32_32x32x16_bf16 v[208:223], v[36:39], v[72:75], v[208:223]
  ds_read_b64_tr_b16 v[60:61], v11 offset:22528
  ds_read_b64_tr_b16 v[62:63], v11 offset:23552
  buffer_load_dwordx4 v5, s[4:7], s70 offen offset:1024 nt lds
  s_waitcnt lgkmcnt(8)
  v_mfma_f32_32x32x16_bf16 v[224:239], v[40:43], v[72:75], v[224:239]
  buffer_load_dwordx4 v6, s[4:7], s70 offen offset:2048 nt lds
  v_mfma_f32_32x32x16_bf16 v[240:255], v[44:47], v[72:75], v[240:255]
  buffer_load_dwordx4 v7, s[4:7], s70 offen offset:3072 nt lds
  s_waitcnt lgkmcnt(4)
  v_mfma_f32_32x32x16_bf16 v[192:207], v[48:51], v[76:79], v[192:207]
  s_add_u32 m0, s81, 81920
  s_add_u32 s70, s83, 16384
  buffer_load_dwordx4 v2, s[8:11], s70 offen offset:0 nt lds
  v_mfma_f32_32x32x16_bf16 v[208:223], v[52:55], v[76:79], v[208:223]
  buffer_load_dwordx4 v2, s[8:11], s70 offen offset:1024 nt lds
  s_waitcnt lgkmcnt(0)
  v_mfma_f32_32x32x16_bf16 v[224:239], v[56:59], v[76:79], v[224:239]
  buffer_load_dwordx4 v2, s[8:11], s70 offen offset:2048 nt lds
  v_mfma_f32_32x32x16_bf16 v[240:255], v[60:63], v[76:79], v[240:255]
  buffer_load_dwordx4 v2, s[8:11], s70 offen offset:3072 nt lds
  s_waitcnt vmcnt(12)
  s_barrier
  v_add_u32 v8, 0x18000, v8
  v_add_u32 v9, 0x18000, v9
  v_add_u32 v10, 0x18000, v10
  v_add_u32 v11, 0x18000, v11
  ds_read_b64_tr_b16 v[32:33], v8 offset:32768
  ds_read_b64_tr_b16 v[34:35], v8 offset:33792
  ds_read_b64_tr_b16 v[36:37], v9 offset:32768
  ds_read_b64_tr_b16 v[38:39], v9 offset:33792
  ds_read_b64_tr_b16 v[40:41], v10 offset:32768
  ds_read_b64_tr_b16 v[42:43], v10 offset:33792
  ds_read_b64_tr_b16 v[44:45], v11 offset:32768
  ds_read_b64_tr_b16 v[46:47], v11 offset:33792
  ds_read_b64_tr_b16 v[48:49], v8 offset:34816
  ds_read_b64_tr_b16 v[50:51], v8 offset:35840
  ds_read_b64_tr_b16 v[52:53], v9 offset:34816
  ds_read_b64_tr_b16 v[54:55], v9 offset:35840
  s_waitcnt lgkmcnt(8)
  v_mfma_f32_32x32x16_bf16 v[192:207], v[32:35], v[80:83], v[192:207]
  ds_read_b64_tr_b16 v[56:57], v10 offset:34816
  ds_read_b64_tr_b16 v[58:59], v10 offset:35840
  s_add_u32 s72, s78, 3
  s_and_b32 s72, s72, 7
  s_lshl_b32 s72, s72, 19
  s_add_u32 s72, s72, s82
  s_add_u32 m0, s81, 98304
  s_add_u32 s71, s72, 256
  buffer_load_dwordx4 v3, s[12:15], s71 offen offset:0 lds
  v_mfma_f32_32x32x16_bf16 v[208:223], v[36:39], v[80:83], v[208:223]
  ds_read_b64_tr_b16 v[60:61], v11 offset:34816
  ds_read_b64_tr_b16 v[62:63], v11 offset:35840
  s_add_u32 s71, s72, 32000
  buffer_load_dwordx4 v3, s[12:15], s71 offen offset:1024 lds
  s_waitcnt lgkmcnt(8)
  v_mfma_f32_32x32x16_bf16 v[224:239], v[40:43], v[80:83], v[224:239]
  ds_read_b64_tr_b16 v[32:33], v8 offset:36864
  ds_read_b64_tr_b16 v[34:35], v8 offset:37888
  s_add_u32 s71, s72, 63744
  buffer_load_dwordx4 v3, s[12:15], s71 offen offset:2048 lds
  v_mfma_f32_32x32x16_bf16 v[240:255], v[44:47], v[80:83], v[240:255]
  ds_read_b64_tr_b16 v[36:37], v9 offset:36864
  ds_read_b64_tr_b16 v[38:39], v9 offset:37888
  s_waitcnt lgkmcnt(8)
  v_mfma_f32_32x32x16_bf16 v[192:207], v[48:51], v[84:87], v[192:207]
  ds_read_b64_tr_b16 v[40:41], v10 offset:36864
  ds_read_b64_tr_b16 v[42:43], v10 offset:37888
  s_add_u32 s71, s72, 95488
  buffer_load_dwordx4 v3, s[12:15], s71 offen offset:3072 lds
  v_mfma_f32_32x32x16_bf16 v[208:223], v[52:55], v[84:87], v[208:223]
  ds_read_b64_tr_b16 v[44:45], v11 offset:36864
  ds_read_b64_tr_b16 v[46:47], v11 offset:37888
  s_add_u32 m0, s81, 0
  s_add_u32 s70, s83, 49152
  buffer_load_dwordx4 v4, s[4:7], s70 offen offset:0 nt lds
  s_waitcnt lgkmcnt(8)
  v_mfma_f32_32x32x16_bf16 v[224:239], v[56:59], v[84:87], v[224:239]
  ds_read_b64_tr_b16 v[48:49], v8 offset:38912
  ds_read_b64_tr_b16 v[50:51], v8 offset:39936
  buffer_load_dwordx4 v5, s[4:7], s70 offen offset:1024 nt lds
  v_mfma_f32_32x32x16_bf16 v[240:255], v[60:63], v[84:87], v[240:255]
  ds_read_b64_tr_b16 v[52:53], v9 offset:38912
  ds_read_b64_tr_b16 v[54:55], v9 offset:39936
  s_waitcnt lgkmcnt(8)
  v_mfma_f32_32x32x16_bf16 v[192:207], v[32:35], v[88:91], v[192:207]
  ds_read_b64_tr_b16 v[56:57], v10 offset:38912
  ds_read_b64_tr_b16 v[58:59], v10 offset:39936
  buffer_load_dwordx4 v6, s[4:7], s70 offen offset:2048 nt lds
  v_mfma_f32_32x32x16_bf16 v[208:223], v[36:39], v[88:91], v[208:223]
  ds_read_b64_tr_b16 v[60:61], v11 offset:38912
  ds_read_b64_tr_b16 v[62:63], v11 offset:39936
  buffer_load_dwordx4 v7, s[4:7], s70 offen offset:3072 nt lds
  s_waitcnt lgkmcnt(8)
  v_mfma_f32_32x32x16_bf16 v[224:239], v[40:43], v[88:91], v[224:239]
  s_add_u32 m0, s81, 16384
  s_add_u32 s70, s83, 32768
  buffer_load_dwordx4 v2, s[8:11], s70 offen offset:0 nt lds
  v_mfma_f32_32x32x16_bf16 v[240:255], v[44:47], v[88:91], v[240:255]
  s_waitcnt lgkmcnt(4)
  v_mfma_f32_32x32x16_bf16 v[192:207], v[48:51], v[92:95], v[192:207]
  buffer_load_dwordx4 v2, s[8:11], s70 offen offset:1024 nt lds
  v_mfma_f32_32x32x16_bf16 v[208:223], v[52:55], v[92:95], v[208:223]
  buffer_load_dwordx4 v2, s[8:11], s70 offen offset:2048 nt lds
  s_waitcnt lgkmcnt(0)
  v_mfma_f32_32x32x16_bf16 v[224:239], v[56:59], v[92:95], v[224:239]
  buffer_load_dwordx4 v2, s[8:11], s70 offen offset:3072 nt lds
  v_mfma_f32_32x32x16_bf16 v[240:255], v[60:63], v[92:95], v[240:255]
  s_waitcnt vmcnt(12)
  s_barrier
  s_or_b32 s70, s63, s65
  s_or_b32 s70, s70, s67
  s_cmp_lg_u32 s70, 0
  s_cbranch_scc1 B_nf2
  v_mov_b32 v28, 0x01010101
  s_mov_b64 exec, 1
  buffer_store_dword v28, off, s[32:35], s85 sc1
  s_mov_b64 exec, -1
B_nf2:
  ds_read_b64_tr_b16 v[32:33], v8 offset:49152
  ds_read_b64_tr_b16 v[34:35], v8 offset:50176
  ds_read_b64_tr_b16 v[36:37], v9 offset:49152
  ds_read_b64_tr_b16 v[38:39], v9 offset:50176
  ds_read_b64_tr_b16 v[40:41], v10 offset:49152
  ds_read_b64_tr_b16 v[42:43], v10 offset:50176
  ds_read_b64_tr_b16 v[44:45], v11 offset:49152
  ds_read_b64_tr_b16 v[46:47], v11 offset:50176
  ds_read_b64_tr_b16 v[48:49], v8 offset:51200
  ds_read_b64_tr_b16 v[50:51], v8 offset:52224
  ds_read_b64_tr_b16 v[52:53], v9 offset:51200
  ds_read_b64_tr_b16 v[54:55], v9 offset:52224
  s_waitcnt lgkmcnt(8)
  v_mfma_f32_32x32x16_bf16 v[192:207], v[32:35], v[96:99], v[192:207]
  ds_read_b64_tr_b16 v[56:57], v10 offset:51200
  ds_read_b64_tr_b16 v[58:59], v10 offset:52224
  s_add_u32 s72, s78, 4
  s_and_b32 s72, s72, 7
  s_lshl_b32 s72, s72, 19
  s_add_u32 s72, s72, s82
  s_add_u32 m0, s81, 114688
  s_add_u32 s71, s72, 256
  buffer_load_dwordx4 v3, s[12:15], s71 offen offset:0 lds
  v_mfma_f32_32x32x16_bf16 v[208:223], v[36:39], v[96:99], v[208:223]
  ds_read_b64_tr_b16 v[60:61], v11 offset:51200
  ds_read_b64_tr_b16 v[62:63], v11 offset:52224
  s_add_u32 s71, s72, 32000
  buffer_load_dwordx4 v3, s[12:15], s71 offen offset:1024 lds
  s_waitcnt lgkmcnt(8)
  v_mfma_f32_32x32x16_bf16 v[224:239], v[40:43], v[96:99], v[224:239]
  ds_read_b64_tr_b16 v[32:33], v8 offset:53248
  ds_read_b64_tr_b16 v[34:35], v8 offset:54272
  s_add_u32 s71, s72, 63744
  buffer_load_dwordx4 v3, s[12:15], s71 offen offset:2048 lds
  v_mfma_f32_32x32x16_bf16 v[240:255], v[44:47], v[96:99], v[240:255]
  ds_read_b64_tr_b16 v[36:37], v9 offset:53248
  ds_read_b64_tr_b16 v[38:39], v9 offset:54272
  s_waitcnt lgkmcnt(8)
  v_mfma_f32_32x32x16_bf16 v[192:207], v[48:51], v[100:103], v[192:207]
  ds_read_b64_tr_b16 v[40:41], v10 offset:53248
  ds_read_b64_tr_b16 v[42:43], v10 offset:54272
  s_add_u32 s71, s72, 95488
  buffer_load_dwordx4 v3, s[12:15], s71 offen offset:3072 lds
  v_mfma_f32_32x32x16_bf16 v[208:223], v[52:55], v[100:103], v[208:223]
  ds_read_b64_tr_b16 v[44:45], v11 offset:53248
  ds_read_b64_tr_b16 v[46:47], v11 offset:54272
  s_add_u32 m0, s81, 32768
  s_add_u32 s70, s83, 65536
  buffer_load_dwordx4 v4, s[4:7], s70 offen offset:0 nt lds
  s_waitcnt lgkmcnt(8)
  v_mfma_f32_32x32x16_bf16 v[224:239], v[56:59], v[100:103], v[224:239]
  ds_read_b64_tr_b16 v[48:49], v8 offset:55296
  ds_read_b64_tr_b16 v[50:51], v8 offset:56320
  buffer_load_dwordx4 v5, s[4:7], s70 offen offset:1024 nt lds
  v_mfma_f32_32x32x16_bf16 v[240:255], v[60:63], v[100:103], v[240:255]
  ds_read_b64_tr_b16 v[52:53], v9 offset:55296
  ds_read_b64_tr_b16 v[54:55], v9 offset:56320
  s_waitcnt lgkmcnt(8)
  v_mfma_f32_32x32x16_bf16 v[192:207], v[32:35], v[104:107], v[192:207]
  ds_read_b64_tr_b16 v[56:57], v10 offset:55296
  ds_read_b64_tr_b16 v[58:59], v10 offset:56320
  buffer_load_dwordx4 v6, s[4:7], s70 offen offset:2048 nt lds
  v_mfma_f32_32x32x16_bf16 v[208:223], v[36:39], v[104:107], v[208:223]
  ds_read_b64_tr_b16 v[60:61], v11 offset:55296
  ds_read_b64_tr_b16 v[62:63], v11 offset:56320
  buffer_load_dwordx4 v7, s[4:7], s70 offen offset:3072 nt lds
  s_waitcnt lgkmcnt(8)
  v_mfma_f32_32x32x16_bf16 v[224:239], v[40:43], v[104:107], v[224:239]
  s_add_u32 m0, s81, 49152
  s_add_u32 s70, s83, 49152
  buffer_load_dwordx4 v2, s[8:11], s70 offen offset:0 nt lds
  v_mfma_f32_32x32x16_bf16 v[240:255], v[44:47], v[104:107], v[240:255]
  s_waitcnt lgkmcnt(4)
  v_mfma_f32_32x32x16_bf16 v[192:207], v[48:51], v[108:111], v[192:207]
  buffer_load_dwordx4 v2, s[8:11], s70 offen offset:1024 nt lds
  v_mfma_f32_32x32x16_bf16 v[208:223], v[52:55], v[108:111], v[208:223]
  buffer_load_dwordx4 v2, s[8:11], s70 offen offset:2048 nt lds
  s_waitcnt lgkmcnt(0)
  v_mfma_f32_32x32x16_bf16 v[224:239], v[56:59], v[108:111], v[224:239]
  buffer_load_dwordx4 v2, s[8:11], s70 offen offset:3072 nt lds
  v_mfma_f32_32x32x16_bf16 v[240:255], v[60:63], v[108:111], v[240:255]
  s_waitcnt vmcnt(12)
  s_barrier
  ds_read_b64_tr_b16 v[32:33], v8 offset:0
  ds_read_b64_tr_b16 v[34:35], v8 offset:1024
  ds_read_b64_tr_b16 v[36:37], v9 offset:0
  ds_read_b64_tr_b16 v[38:39], v9 offset:1024
  ds_read_b64_tr_b16 v[40:41], v10 offset:0
  ds_read_b64_tr_b16 v[42:43], v10 offset:1024
  ds_read_b64_tr_b16 v[44:45], v11 offset:0
  ds_read_b64_tr_b16 v[46:47], v11 offset:1024
  ds_read_b64_tr_b16 v[48:49], v8 offset:2048
  ds_read_b64_tr_b16 v[50:51], v8 offset:3072
  ds_read_b64_tr_b16 v[52:53], v9 offset:2048
  ds_read_b64_tr_b16 v[54:55], v9 offset:3072
  s_waitcnt lgkmcnt(8)
  v_mfma_f32_32x32x16_bf16 v[192:207], v[32:35], v[112:115], v[192:207]
  ds_read_b64_tr_b16 v[56:57], v10 offset:2048
  ds_read_b64_tr_b16 v[58:59], v10 offset:3072
  s_add_u32 s72, s78, 5
  s_and_b32 s72, s72, 7
  s_lshl_b32 s72, s72, 19
  s_add_u32 s72, s72, s82
  s_add_u32 m0, s81, 131072
  s_add_u32 s71, s72, 256
  buffer_load_dwordx4 v3, s[12:15], s71 offen offset:0 lds
  v_mfma_f32_32x32x16_bf16 v[208:223], v[36:39], v[112:115], v[208:223]
  ds_read_b64_tr_b16 v[60:61], v11 offset:2048
  ds_read_b64_tr_b16 v[62:63], v11 offset:3072
  s_add_u32 s71, s72, 32000
  buffer_load_dwordx4 v3, s[12:15], s71 offen offset:1024 lds
  s_waitcnt lgkmcnt(8)
  v_mfma_f32_32x32x16_bf16 v[224:239], v[40:43], v[112:115], v[224:239]
  ds_read_b64_tr_b16 v[32:33], v8 offset:4096
  ds_read_b64_tr_b16 v[34:35], v8 offset:5120
  s_add_u32 s71, s72, 63744
  buffer_load_dwordx4 v3, s[12:15], s71 offen offset:2048 lds
  v_mfma_f32_32x32x16_bf16 v[240:255], v[44:47], v[112:115], v[240:255]
  ds_read_b64_tr_b16 v[36:37], v9 offset:4096
  ds_read_b64_tr_b16 v[38:39], v9 offset:5120
  s_waitcnt lgkmcnt(8)
  v_mfma_f32_32x32x16_bf16 v[192:207], v[48:51], v[116:119], v[192:207]
  ds_read_b64_tr_b16 v[40:41], v10 offset:4096
  ds_read_b64_tr_b16 v[42:43], v10 offset:5120
  s_add_u32 s71, s72, 95488
  buffer_load_dwordx4 v3, s[12:15], s71 offen offset:3072 lds
  v_mfma_f32_32x32x16_bf16 v[208:223], v[52:55], v[116:119], v[208:223]
  ds_read_b64_tr_b16 v[44:45], v11 offset:4096
  ds_read_b64_tr_b16 v[46:47], v11 offset:5120
  s_add_u32 m0, s81, 65536
  s_add_u32 s70, s83, 81920
  buffer_load_dwordx4 v4, s[4:7], s70 offen offset:0 nt lds
  s_waitcnt lgkmcnt(8)
  v_mfma_f32_32x32x16_bf16 v[224:239], v[56:59], v[116:119], v[224:239]
  ds_read_b64_tr_b16 v[48:49], v8 offset:6144
  ds_read_b64_tr_b16 v[50:51], v8 offset:7168
  buffer_load_dwordx4 v5, s[4:7], s70 offen offset:1024 nt lds
  v_mfma_f32_32x32x16_bf16 v[240:255], v[60:63], v[116:119], v[240:255]
  ds_read_b64_tr_b16 v[52:53], v9 offset:6144
  ds_read_b64_tr_b16 v[54:55], v9 offset:7168
  s_waitcnt lgkmcnt(8)
  v_mfma_f32_32x32x16_bf16 v[192:207], v[32:35], v[120:123], v[192:207]
  ds_read_b64_tr_b16 v[56:57], v10 offset:6144
  ds_read_b64_tr_b16 v[58:59], v10 offset:7168
  buffer_load_dwordx4 v6, s[4:7], s70 offen offset:2048 nt lds
  v_mfma_f32_32x32x16_bf16 v[208:223], v[36:39], v[120:123], v[208:223]
  ds_read_b64_tr_b16 v[60:61], v11 offset:6144
  ds_read_b64_tr_b16 v[62:63], v11 offset:7168
  buffer_load_dwordx4 v7, s[4:7], s70 offen offset:3072 nt lds
  s_waitcnt lgkmcnt(8)
  v_mfma_f32_32x32x16_bf16 v[224:239], v[40:43], v[120:123], v[224:239]
  s_add_u32 m0, s81, 81920
  s_add_u32 s70, s83, 65536
  buffer_load_dwordx4 v2, s[8:11], s70 offen offset:0 nt lds
  v_mfma_f32_32x32x16_bf16 v[240:255], v[44:47], v[120:123], v[240:255]
  s_waitcnt lgkmcnt(4)
  v_mfma_f32_32x32x16_bf16 v[192:207], v[48:51], v[124:127], v[192:207]
  buffer_load_dwordx4 v2, s[8:11], s70 offen offset:1024 nt lds
  v_mfma_f32_32x32x16_bf16 v[208:223], v[52:55], v[124:127], v[208:223]
  buffer_load_dwordx4 v2, s[8:11], s70 offen offset:2048 nt lds
  s_waitcnt lgkmcnt(0)
  v_mfma_f32_32x32x16_bf16 v[224:239], v[56:59], v[124:127], v[224:239]
  buffer_load_dwordx4 v2, s[8:11], s70 offen offset:3072 nt lds
  v_mfma_f32_32x32x16_bf16 v[240:255], v[60:63], v[124:127], v[240:255]
  s_waitcnt vmcnt(12)
  s_barrier
  ds_read_b64_tr_b16 v[32:33], v8 offset:16384
  ds_read_b64_tr_b16 v[34:35], v8 offset:17408
  ds_read_b64_tr_b16 v[36:37], v9 offset:16384
  ds_read_b64_tr_b16 v[38:39], v9 offset:17408
  ds_read_b64_tr_b16 v[40:41], v10 offset:16384
  ds_read_b64_tr_b16 v[42:43], v10 offset:17408
  ds_read_b64_tr_b16 v[44:45], v11 offset:16384
  ds_read_b64_tr_b16 v[46:47], v11 offset:17408
  ds_read_b64_tr_b16 v[48:49], v8 offset:18432
  ds_read_b64_tr_b16 v[50:51], v8 offset:19456
  ds_read_b64_tr_b16 v[52:53], v9 offset:18432
  ds_read_b64_tr_b16 v[54:55], v9 offset:19456
  s_waitcnt lgkmcnt(8)
  v_mfma_f32_32x32x16_bf16 v[192:207], v[32:35], v[128:131], v[192:207]
  ds_read_b64_tr_b16 v[56:57], v10 offset:18432
  ds_read_b64_tr_b16 v[58:59], v10 offset:19456
  s_add_u32 s72, s78, 6
  s_and_b32 s72, s72, 7
  s_lshl_b32 s72, s72, 19
  s_add_u32 s72, s72, s82
  s_add_u32 m0, s81, 147456
  s_add_u32 s71, s72, 256
  buffer_load_dwordx4 v3, s[12:15], s71 offen offset:0 lds
  v_mfma_f32_32x32x16_bf16 v[208:223], v[36:39], v[128:131], v[208:223]
  ds_read_b64_tr_b16 v[60:61], v11 offset:18432
  ds_read_b64_tr_b16 v[62:63], v11 offset:19456
  s_add_u32 s71, s72, 32000
  buffer_load_dwordx4 v3, s[12:15], s71 offen offset:1024 lds
  s_waitcnt lgkmcnt(8)
  v_mfma_f32_32x32x16_bf16 v[224:239], v[40:43], v[128:131], v[224:239]
  ds_read_b64_tr_b16 v[32:33], v8 offset:20480
  ds_read_b64_tr_b16 v[34:35], v8 offset:21504
  s_add_u32 s71, s72, 63744
  buffer_load_dwordx4 v3, s[12:15], s71 offen offset:2048 lds
  v_mfma_f32_32x32x16_bf16 v[240:255], v[44:47], v[128:131], v[240:255]
  ds_read_b64_tr_b16 v[36:37], v9 offset:20480
  ds_read_b64_tr_b16 v[38:39], v9 offset:21504
  s_waitcnt lgkmcnt(8)
  v_mfma_f32_32x32x16_bf16 v[192:207], v[48:51], v[132:135], v[192:207]
  ds_read_b64_tr_b16 v[40:41], v10 offset:20480
  ds_read_b64_tr_b16 v[42:43], v10 offset:21504
  s_add_u32 s71, s72, 95488
  buffer_load_dwordx4 v3, s[12:15], s71 offen offset:3072 lds
  v_mfma_f32_32x32x16_bf16 v[208:223], v[52:55], v[132:135], v[208:223]
  ds_read_b64_tr_b16 v[44:45], v11 offset:20480
  ds_read_b64_tr_b16 v[46:47], v11 offset:21504
  s_add_u32 m0, s81, 0
  s_add_u32 s70, s83, 98304
  buffer_load_dwordx4 v4, s[4:7], s70 offen offset:0 nt lds
  s_waitcnt lgkmcnt(8)
  v_mfma_f32_32x32x16_bf16 v[224:239], v[56:59], v[132:135], v[224:239]
  ds_read_b64_tr_b16 v[48:49], v8 offset:22528
  ds_read_b64_tr_b16 v[50:51], v8 offset:23552
  buffer_load_dwordx4 v5, s[4:7], s70 offen offset:1024 nt lds
  v_mfma_f32_32x32x16_bf16 v[240:255], v[60:63], v[132:135], v[240:255]
  ds_read_b64_tr_b16 v[52:53], v9 offset:22528
  ds_read_b64_tr_b16 v[54:55], v9 offset:23552
  s_waitcnt lgkmcnt(8)
  v_mfma_f32_32x32x16_bf16 v[192:207], v[32:35], v[136:139], v[192:207]
  ds_read_b64_tr_b16 v[56:57], v10 offset:22528
  ds_read_b64_tr_b16 v[58:59], v10 offset:23552
  buffer_load_dwordx4 v6, s[4:7], s70 offen offset:2048 nt lds
  v_mfma_f32_32x32x16_bf16 v[208:223], v[36:39], v[136:139], v[208:223]
  ds_read_b64_tr_b16 v[60:61], v11 offset:22528
  ds_read_b64_tr_b16 v[62:63], v11 offset:23552
  buffer_load_dwordx4 v7, s[4:7], s70 offen offset:3072 nt lds
  s_waitcnt lgkmcnt(8)
  v_mfma_f32_32x32x16_bf16 v[224:239], v[40:43], v[136:139], v[224:239]
  s_add_u32 m0, s81, 16384
  s_add_u32 s70, s83, 81920
  buffer_load_dwordx4 v2, s[8:11], s70 offen offset:0 nt lds
  v_mfma_f32_32x32x16_bf16 v[240:255], v[44:47], v[136:139], v[240:255]
  s_waitcnt lgkmcnt(4)
  v_mfma_f32_32x32x16_bf16 v[192:207], v[48:51], v[140:143], v[192:207]
  buffer_load_dwordx4 v2, s[8:11], s70 offen offset:1024 nt lds
  v_mfma_f32_32x32x16_bf16 v[208:223], v[52:55], v[140:143], v[208:223]
  buffer_load_dwordx4 v2, s[8:11], s70 offen offset:2048 nt lds
  s_waitcnt lgkmcnt(0)
  v_mfma_f32_32x32x16_bf16 v[224:239], v[56:59], v[140:143], v[224:239]
  buffer_load_dwordx4 v2, s[8:11], s70 offen offset:3072 nt lds
  v_mfma_f32_32x32x16_bf16 v[240:255], v[60:63], v[140:143], v[240:255]
  s_waitcnt vmcnt(12)
  s_barrier
  ds_read_b64_tr_b16 v[32:33], v8 offset:32768
  ds_read_b64_tr_b16 v[34:35], v8 offset:33792
  ds_read_b64_tr_b16 v[36:37], v9 offset:32768
  ds_read_b64_tr_b16 v[38:39], v9 offset:33792
  ds_read_b64_tr_b16 v[40:41], v10 offset:32768
  ds_read_b64_tr_b16 v[42:43], v10 offset:33792
  ds_read_b64_tr_b16 v[44:45], v11 offset:32768
  ds_read_b64_tr_b16 v[46:47], v11 offset:33792
  ds_read_b64_tr_b16 v[48:49], v8 offset:34816
  ds_read_b64_tr_b16 v[50:51], v8 offset:35840
  ds_read_b64_tr_b16 v[52:53], v9 offset:34816
  ds_read_b64_tr_b16 v[54:55], v9 offset:35840
  s_waitcnt lgkmcnt(8)
  v_mfma_f32_32x32x16_bf16 v[192:207], v[32:35], v[144:147], v[192:207]
  ds_read_b64_tr_b16 v[56:57], v10 offset:34816
  ds_read_b64_tr_b16 v[58:59], v10 offset:35840
  s_add_u32 s72, s78, 7
  s_and_b32 s72, s72, 7
  s_lshl_b32 s72, s72, 19
  s_add_u32 s72, s72, s82
  s_add_u32 m0, s81, 98304
  s_add_u32 s71, s72, 256
  buffer_load_dwordx4 v3, s[12:15], s71 offen offset:0 lds
  v_mfma_f32_32x32x16_bf16 v[208:223], v[36:39], v[144:147], v[208:223]
  ds_read_b64_tr_b16 v[60:61], v11 offset:34816
  ds_read_b64_tr_b16 v[62:63], v11 offset:35840
  s_add_u32 s71, s72, 32000
  buffer_load_dwordx4 v3, s[12:15], s71 offen offset:1024 lds
  s_waitcnt lgkmcnt(8)
  v_mfma_f32_32x32x16_bf16 v[224:239], v[40:43], v[144:147], v[224:239]
  ds_read_b64_tr_b16 v[32:33], v8 offset:36864
  ds_read_b64_tr_b16 v[34:35], v8 offset:37888
  s_add_u32 s71, s72, 63744
  buffer_load_dwordx4 v3, s[12:15], s71 offen offset:2048 lds
  v_mfma_f32_32x32x16_bf16 v[240:255], v[44:47], v[144:147], v[240:255]
  ds_read_b64_tr_b16 v[36:37], v9 offset:36864
  ds_read_b64_tr_b16 v[38:39], v9 offset:37888
  s_waitcnt lgkmcnt(8)
  v_mfma_f32_32x32x16_bf16 v[192:207], v[48:51], v[148:151], v[192:207]
  ds_read_b64_tr_b16 v[40:41], v10 offset:36864
  ds_read_b64_tr_b16 v[42:43], v10 offset:37888
  s_add_u32 s71, s72, 95488
  buffer_load_dwordx4 v3, s[12:15], s71 offen offset:3072 lds
  v_mfma_f32_32x32x16_bf16 v[208:223], v[52:55], v[148:151], v[208:223]
  ds_read_b64_tr_b16 v[44:45], v11 offset:36864
  ds_read_b64_tr_b16 v[46:47], v11 offset:37888
  s_add_u32 m0, s81, 32768
  s_add_u32 s70, s83, 114688
  buffer_load_dwordx4 v4, s[4:7], s70 offen offset:0 nt lds
  s_waitcnt lgkmcnt(8)
  v_mfma_f32_32x32x16_bf16 v[224:239], v[56:59], v[148:151], v[224:239]
  ds_read_b64_tr_b16 v[48:49], v8 offset:38912
  ds_read_b64_tr_b16 v[50:51], v8 offset:39936
  buffer_load_dwordx4 v5, s[4:7], s70 offen offset:1024 nt lds
  v_mfma_f32_32x32x16_bf16 v[240:255], v[60:63], v[148:151], v[240:255]
  ds_read_b64_tr_b16 v[52:53], v9 offset:38912
  ds_read_b64_tr_b16 v[54:55], v9 offset:39936
  s_waitcnt lgkmcnt(8)
  v_mfma_f32_32x32x16_bf16 v[192:207], v[32:35], v[152:155], v[192:207]
  ds_read_b64_tr_b16 v[56:57], v10 offset:38912
  ds_read_b64_tr_b16 v[58:59], v10 offset:39936
  buffer_load_dwordx4 v6, s[4:7], s70 offen offset:2048 nt lds
  v_mfma_f32_32x32x16_bf16 v[208:223], v[36:39], v[152:155], v[208:223]
  ds_read_b64_tr_b16 v[60:61], v11 offset:38912
  ds_read_b64_tr_b16 v[62:63], v11 offset:39936
  buffer_load_dwordx4 v7, s[4:7], s70 offen offset:3072 nt lds
  s_waitcnt lgkmcnt(8)
  v_mfma_f32_32x32x16_bf16 v[224:239], v[40:43], v[152:155], v[224:239]
  s_add_u32 m0, s81, 49152
  s_add_u32 s70, s83, 98304
  buffer_load_dwordx4 v2, s[8:11], s70 offen offset:0 nt lds
  v_mfma_f32_32x32x16_bf16 v[240:255], v[44:47], v[152:155], v[240:255]
  s_waitcnt lgkmcnt(4)
  v_mfma_f32_32x32x16_bf16 v[192:207], v[48:51], v[156:159], v[192:207]
  buffer_load_dwordx4 v2, s[8:11], s70 offen offset:1024 nt lds
  v_mfma_f32_32x32x16_bf16 v[208:223], v[52:55], v[156:159], v[208:223]
  buffer_load_dwordx4 v2, s[8:11], s70 offen offset:2048 nt lds
  s_waitcnt lgkmcnt(0)
  v_mfma_f32_32x32x16_bf16 v[224:239], v[56:59], v[156:159], v[224:239]
  buffer_load_dwordx4 v2, s[8:11], s70 offen offset:3072 nt lds
  v_mfma_f32_32x32x16_bf16 v[240:255], v[60:63], v[156:159], v[240:255]
  s_waitcnt vmcnt(12)
  s_barrier
  ds_read_b64_tr_b16 v[32:33], v8 offset:49152
  ds_read_b64_tr_b16 v[34:35], v8 offset:50176
  ds_read_b64_tr_b16 v[36:37], v9 offset:49152
  ds_read_b64_tr_b16 v[38:39], v9 offset:50176
  ds_read_b64_tr_b16 v[40:41], v10 offset:49152
  ds_read_b64_tr_b16 v[42:43], v10 offset:50176
  ds_read_b64_tr_b16 v[44:45], v11 offset:49152
  ds_read_b64_tr_b16 v[46:47], v11 offset:50176
  ds_read_b64_tr_b16 v[48:49], v8 offset:51200
  ds_read_b64_tr_b16 v[50:51], v8 offset:52224
  ds_read_b64_tr_b16 v[52:53], v9 offset:51200
  ds_read_b64_tr_b16 v[54:55], v9 offset:52224
  s_waitcnt lgkmcnt(8)
  v_mfma_f32_32x32x16_bf16 v[192:207], v[32:35], v[160:163], v[192:207]
  ds_read_b64_tr_b16 v[56:57], v10 offset:51200
  ds_read_b64_tr_b16 v[58:59], v10 offset:52224
  s_add_u32 m0, s81, 65536
  s_add_u32 s70, s83, 131072
  buffer_load_dwordx4 v4, s[4:7], s70 offen offset:0 nt lds
  v_mfma_f32_32x32x16_bf16 v[208:223], v[36:39], v[160:163], v[208:223]
  ds_read_b64_tr_b16 v[60:61], v11 offset:51200
  ds_read_b64_tr_b16 v[62:63], v11 offset:52224
  s_waitcnt lgkmcnt(8)
  v_mfma_f32_32x32x16_bf16 v[224:239], v[40:43], v[160:163], v[224:239]
  ds_read_b64_tr_b16 v[32:33], v8 offset:53248
  ds_read_b64_tr_b16 v[34:35], v8 offset:54272
  buffer_load_dwordx4 v5, s[4:7], s70 offen offset:1024 nt lds
  v_mfma_f32_32x32x16_bf16 v[240:255], v[44:47], v[160:163], v[240:255]
  ds_read_b64_tr_b16 v[36:37], v9 offset:53248
  ds_read_b64_tr_b16 v[38:39], v9 offset:54272
  s_waitcnt lgkmcnt(8)
  v_mfma_f32_32x32x16_bf16 v[192:207], v[48:51], v[164:167], v[192:207]
  ds_read_b64_tr_b16 v[40:41], v10 offset:53248
  ds_read_b64_tr_b16 v[42:43], v10 offset:54272
  buffer_load_dwordx4 v6, s[4:7], s70 offen offset:2048 nt lds
  v_mfma_f32_32x32x16_bf16 v[208:223], v[52:55], v[164:167], v[208:223]
  ds_read_b64_tr_b16 v[44:45], v11 offset:53248
  ds_read_b64_tr_b16 v[46:47], v11 offset:54272
  s_waitcnt lgkmcnt(8)
  v_mfma_f32_32x32x16_bf16 v[224:239], v[56:59], v[164:167], v[224:239]
  ds_read_b64_tr_b16 v[48:49], v8 offset:55296
  ds_read_b64_tr_b16 v[50:51], v8 offset:56320
  buffer_load_dwordx4 v7, s[4:7], s70 offen offset:3072 nt lds
  v_mfma_f32_32x32x16_bf16 v[240:255], v[60:63], v[164:167], v[240:255]
  ds_read_b64_tr_b16 v[52:53], v9 offset:55296
  ds_read_b64_tr_b16 v[54:55], v9 offset:56320
  s_waitcnt lgkmcnt(8)
  v_mfma_f32_32x32x16_bf16 v[192:207], v[32:35], v[168:171], v[192:207]
  ds_read_b64_tr_b16 v[56:57], v10 offset:55296
  ds_read_b64_tr_b16 v[58:59], v10 offset:56320
  s_add_u32 m0, s81, 81920
  s_add_u32 s70, s83, 114688
  buffer_load_dwordx4 v2, s[8:11], s70 offen offset:0 nt lds
  v_mfma_f32_32x32x16_bf16 v[208:223], v[36:39], v[168:171], v[208:223]
  ds_read_b64_tr_b16 v[60:61], v11 offset:55296
  ds_read_b64_tr_b16 v[62:63], v11 offset:56320
  s_waitcnt lgkmcnt(8)
  v_mfma_f32_32x32x16_bf16 v[224:239], v[40:43], v[168:171], v[224:239]
  buffer_load_dwordx4 v2, s[8:11], s70 offen offset:1024 nt lds
  v_mfma_f32_32x32x16_bf16 v[240:255], v[44:47], v[168:171], v[240:255]
  s_waitcnt lgkmcnt(4)
  v_mfma_f32_32x32x16_bf16 v[192:207], v[48:51], v[172:175], v[192:207]
  buffer_load_dwordx4 v2, s[8:11], s70 offen offset:2048 nt lds
  v_mfma_f32_32x32x16_bf16 v[208:223], v[52:55], v[172:175], v[208:223]
  s_waitcnt lgkmcnt(0)
  v_mfma_f32_32x32x16_bf16 v[224:239], v[56:59], v[172:175], v[224:239]
  buffer_load_dwordx4 v2, s[8:11], s70 offen offset:3072 nt lds
  v_mfma_f32_32x32x16_bf16 v[240:255], v[60:63], v[172:175], v[240:255]
  s_waitcnt vmcnt(8)
  s_barrier
  ds_read_b64_tr_b16 v[32:33], v8 offset:0
  ds_read_b64_tr_b16 v[34:35], v8 offset:1024
  ds_read_b64_tr_b16 v[36:37], v8 offset:2048
  ds_read_b64_tr_b16 v[38:39], v8 offset:3072
  ds_read_b64_tr_b16 v[40:41], v8 offset:4096
  ds_read_b64_tr_b16 v[42:43], v8 offset:5120
  ds_read_b64_tr_b16 v[44:45], v8 offset:6144
  ds_read_b64_tr_b16 v[46:47], v8 offset:7168
  ds_read_b64_tr_b16 v[48:49], v9 offset:0
  ds_read_b64_tr_b16 v[50:51], v9 offset:1024
  ds_read_b64_tr_b16 v[52:53], v9 offset:2048
  ds_read_b64_tr_b16 v[54:55], v9 offset:3072
  s_waitcnt lgkmcnt(8)
  v_mfma_f32_32x32x16_bf16 v[192:207], v[32:35], v[176:179], v[192:207]
  ds_read_b64_tr_b16 v[56:57], v9 offset:4096
  ds_read_b64_tr_b16 v[58:59], v9 offset:5120
  s_add_u32 m0, s81, 147456
  s_add_u32 s72, s54, s77
  s_add_u32 s71, s72, 0
  buffer_load_dwordx4 v12, s[24:27], s71 offen offset:0 lds
  v_mfma_f32_32x32x16_bf16 v[192:207], v[36:39], v[180:183], v[192:207]
  ds_read_b64_tr_b16 v[60:61], v9 offset:6144
  ds_read_b64_tr_b16 v[62:63], v9 offset:7168
  s_add_u32 s71, s72, 3072
  buffer_load_dwordx4 v12, s[24:27], s71 offen offset:1024 lds
  s_waitcnt lgkmcnt(8)
  v_mfma_f32_32x32x16_bf16 v[192:207], v[40:43], v[184:187], v[192:207]
  ds_read_b64_tr_b16 v[32:33], v10 offset:0
  ds_read_b64_tr_b16 v[34:35], v10 offset:1024
  s_add_u32 s71, s72, 6144
  buffer_load_dwordx4 v12, s[24:27], s71 offen offset:2048 lds
  v_mfma_f32_32x32x16_bf16 v[192:207], v[44:47], v[188:191], v[192:207]
  ds_read_b64_tr_b16 v[36:37], v10 offset:2048
  ds_read_b64_tr_b16 v[38:39], v10 offset:3072
  s_waitcnt lgkmcnt(8)
  v_mfma_f32_32x32x16_bf16 v[208:223], v[48:51], v[176:179], v[208:223]
  ds_read_b64_tr_b16 v[40:41], v10 offset:4096
  ds_read_b64_tr_b16 v[42:43], v10 offset:5120
  s_add_u32 s71, s72, 9216
  buffer_load_dwordx4 v12, s[24:27], s71 offen offset:3072 lds
  v_mfma_f32_32x32x16_bf16 v[208:223], v[52:55], v[180:183], v[208:223]
  ds_read_b64_tr_b16 v[44:45], v10 offset:6144
  ds_read_b64_tr_b16 v[46:47], v10 offset:7168
  s_add_u32 m0, s81, 0
  s_add_u32 s70, s83, 147456
  buffer_load_dwordx4 v4, s[4:7], s70 offen offset:0 nt lds
  v_pk_mul_f32 v[192:193], v[192:193], s[74:75] op_sel_hi:[1,0]
  v_pk_mul_f32 v[194:195], v[194:195], s[74:75] op_sel_hi:[1,0]
  v_pk_mul_f32 v[196:197], v[196:197], s[74:75] op_sel_hi:[1,0]
  v_pk_mul_f32 v[198:199], v[198:199], s[74:75] op_sel_hi:[1,0]
  v_pk_mul_f32 v[200:201], v[200:201], s[74:75] op_sel_hi:[1,0]
  s_waitcnt lgkmcnt(8)
  v_mfma_f32_32x32x16_bf16 v[208:223], v[56:59], v[184:187], v[208:223]
  ds_read_b64_tr_b16 v[48:49], v11 offset:0
  ds_read_b64_tr_b16 v[50:51], v11 offset:1024
  buffer_load_dwordx4 v5, s[4:7], s70 offen offset:1024 nt lds
  v_pk_mul_f32 v[202:203], v[202:203], s[74:75] op_sel_hi:[1,0]
  v_pk_mul_f32 v[204:205], v[204:205], s[74:75] op_sel_hi:[1,0]
  v_pk_mul_f32 v[206:207], v[206:207], s[74:75] op_sel_hi:[1,0]
  v_cvt_pk_bf16_f32 v192, v192, v193
  v_mfma_f32_32x32x16_bf16 v[208:223], v[60:63], v[188:191], v[208:223]
  ds_read_b64_tr_b16 v[52:53], v11 offset:2048
  ds_read_b64_tr_b16 v[54:55], v11 offset:3072
  v_cvt_pk_bf16_f32 v193, v194, v195
  v_cvt_pk_bf16_f32 v194, v196, v197
  v_cvt_pk_bf16_f32 v195, v198, v199
  ds_write_b128 v14, v[192:195] offset:16384
  v_cvt_pk_bf16_f32 v196, v200, v201
  s_waitcnt lgkmcnt(8)
  v_mfma_f32_32x32x16_bf16 v[224:239], v[32:35], v[176:179], v[224:239]
  ds_read_b64_tr_b16 v[56:57], v11 offset:4096
  ds_read_b64_tr_b16 v[58:59], v11 offset:5120
  buffer_load_dwordx4 v6, s[4:7], s70 offen offset:2048 nt lds
  v_cvt_pk_bf16_f32 v197, v202, v203
  v_cvt_pk_bf16_f32 v198, v204, v205
  v_cvt_pk_bf16_f32 v199, v206, v207
  ds_write_b128 v14, v[196:199] offset:17408
  v_mfma_f32_32x32x16_bf16 v[224:239], v[36:39], v[180:183], v[224:239]
  ds_read_b64_tr_b16 v[60:61], v11 offset:6144
  ds_read_b64_tr_b16 v[62:63], v11 offset:7168
  buffer_load_dwordx4 v7, s[4:7], s70 offen offset:3072 nt lds
  v_pk_mul_f32 v[208:209], v[208:209], s[74:75] op_sel_hi:[1,0]
  v_pk_mul_f32 v[210:211], v[210:211], s[74:75] op_sel_hi:[1,0]
  v_pk_mul_f32 v[212:213], v[212:213], s[74:75] op_sel_hi:[1,0]
  v_pk_mul_f32 v[214:215], v[214:215], s[74:75] op_sel_hi:[1,0]
  v_pk_mul_f32 v[216:217], v[216:217], s[74:75] op_sel_hi:[1,0]
  s_waitcnt lgkmcnt(8)
  v_mfma_f32_32x32x16_bf16 v[224:239], v[40:43], v[184:187], v[224:239]
  s_add_u32 m0, s81, 16384
  s_add_u32 s70, s83, 131072
  buffer_load_dwordx4 v2, s[8:11], s70 offen offset:0 nt lds
  v_pk_mul_f32 v[218:219], v[218:219], s[74:75] op_sel_hi:[1,0]
  v_pk_mul_f32 v[220:221], v[220:221], s[74:75] op_sel_hi:[1,0]
  v_pk_mul_f32 v[222:223], v[222:223], s[74:75] op_sel_hi:[1,0]
  v_cvt_pk_bf16_f32 v208, v208, v209
  v_mfma_f32_32x32x16_bf16 v[224:239], v[44:47], v[188:191], v[224:239]
  v_cvt_pk_bf16_f32 v209, v210, v211
  v_cvt_pk_bf16_f32 v210, v212, v213
  v_cvt_pk_bf16_f32 v211, v214, v215
  ds_write_b128 v14, v[208:211] offset:18432
  v_cvt_pk_bf16_f32 v212, v216, v217
  s_waitcnt lgkmcnt(4)
  v_mfma_f32_32x32x16_bf16 v[240:255], v[48:51], v[176:179], v[240:255]
  buffer_load_dwordx4 v2, s[8:11], s70 offen offset:1024 nt lds
  v_cvt_pk_bf16_f32 v213, v218, v219
  v_cvt_pk_bf16_f32 v214, v220, v221
  v_cvt_pk_bf16_f32 v215, v222, v223
  ds_write_b128 v14, v[212:215] offset:19456
  v_mfma_f32_32x32x16_bf16 v[240:255], v[52:55], v[180:183], v[240:255]
  buffer_load_dwordx4 v2, s[8:11], s70 offen offset:2048 nt lds
  v_pk_mul_f32 v[224:225], v[224:225], s[74:75] op_sel_hi:[1,0]
  v_pk_mul_f32 v[226:227], v[226:227], s[74:75] op_sel_hi:[1,0]
  v_pk_mul_f32 v[228:229], v[228:229], s[74:75] op_sel_hi:[1,0]
  v_pk_mul_f32 v[230:231], v[230:231], s[74:75] op_sel_hi:[1,0]
  v_pk_mul_f32 v[232:233], v[232:233], s[74:75] op_sel_hi:[1,0]
  v_pk_mul_f32 v[234:235], v[234:235], s[74:75] op_sel_hi:[1,0]
  s_waitcnt lgkmcnt(0)
  v_mfma_f32_32x32x16_bf16 v[240:255], v[56:59], v[184:187], v[240:255]
  buffer_load_dwordx4 v2, s[8:11], s70 offen offset:3072 nt lds
  v_pk_mul_f32 v[236:237], v[236:237], s[74:75] op_sel_hi:[1,0]
  v_pk_mul_f32 v[238:239], v[238:239], s[74:75] op_sel_hi:[1,0]
  v_cvt_pk_bf16_f32 v224, v224, v225
  v_cvt_pk_bf16_f32 v225, v226, v227
  v_cvt_pk_bf16_f32 v226, v228, v229
  v_cvt_pk_bf16_f32 v227, v230, v231
  v_mfma_f32_32x32x16_bf16 v[240:255], v[60:63], v[188:191], v[240:255]
  ds_write_b128 v14, v[224:227] offset:20480
  v_cvt_pk_bf16_f32 v228, v232, v233
  v_cvt_pk_bf16_f32 v229, v234, v235
  v_cvt_pk_bf16_f32 v230, v236, v237
  v_cvt_pk_bf16_f32 v231, v238, v239
  ds_write_b128 v14, v[228:231] offset:21504
  s_nop 5
  v_pk_mul_f32 v[240:241], v[240:241], s[74:75] op_sel_hi:[1,0]
  v_pk_mul_f32 v[242:243], v[242:243], s[74:75] op_sel_hi:[1,0]
  v_pk_mul_f32 v[244:245], v[244:245], s[74:75] op_sel_hi:[1,0]
  v_pk_mul_f32 v[246:247], v[246:247], s[74:75] op_sel_hi:[1,0]
  v_pk_mul_f32 v[248:249], v[248:249], s[74:75] op_sel_hi:[1,0]
  v_pk_mul_f32 v[250:251], v[250:251], s[74:75] op_sel_hi:[1,0]
  v_pk_mul_f32 v[252:253], v[252:253], s[74:75] op_sel_hi:[1,0]
  v_pk_mul_f32 v[254:255], v[254:255], s[74:75] op_sel_hi:[1,0]
  v_cvt_pk_bf16_f32 v240, v240, v241
  v_cvt_pk_bf16_f32 v241, v242, v243
  v_cvt_pk_bf16_f32 v242, v244, v245
  v_cvt_pk_bf16_f32 v243, v246, v247
  ds_write_b128 v14, v[240:243] offset:22528
  v_cvt_pk_bf16_f32 v244, v248, v249
  v_cvt_pk_bf16_f32 v245, v250, v251
  v_cvt_pk_bf16_f32 v246, v252, v253
  v_cvt_pk_bf16_f32 v247, v254, v255
  ds_write_b128 v14, v[244:247] offset:23552
  s_waitcnt lgkmcnt(0)
  s_waitcnt vmcnt(12)
  s_barrier
  s_add_u32 s70, s65, 1
  s_and_b32 s70, s70, 3
  v_xor_b32 v29, s70, v17
  v_lshlrev_b32 v29, 6, v29
  v_add_u32 v29, v29, v15
  v_add_u32 v8, 98304, v29
  s_add_u32 s70, s65, 2
  s_and_b32 s70, s70, 3
  v_xor_b32 v29, s70, v17
  v_lshlrev_b32 v29, 6, v29
  v_add_u32 v29, v29, v15
  v_add_u32 v9, 98304, v29
  s_add_u32 s70, s65, 3
  s_and_b32 s70, s70, 3
  v_xor_b32 v29, s70, v17
  v_lshlrev_b32 v29, 6, v29
  v_add_u32 v29, v29, v15
  v_add_u32 v10, 98304, v29
  s_add_u32 s70, s65, 4
  s_and_b32 s70, s70, 3
  v_xor_b32 v29, s70, v17
  v_lshlrev_b32 v29, 6, v29
  v_add_u32 v29, v29, v15
  v_add_u32 v11, 98304, v29
  s_and_b32 s71, s85, 0xfffffff0
  buffer_load_dword v24, off, s[32:35], s71
  s_lshr_b32 s72, s85, 4
  s_lshl_b32 s72, s72, 2
  s_add_u32 s72, s72, s67
  s_lshl_b32 s72, s72, 7
  s_lshl_b32 s71, s63, 2
  s_add_u32 s72, s72, s71
  s_add_u32 s72, s72, 33619968
  buffer_load_dword v25, off, s[20:23], s72 sc1
  s_add_u32 m0, s81, 98304
  s_add_u32 s72, s54, s79
  s_add_u32 s71, s72, 0
  buffer_load_dwordx4 v12, s[24:27], s71 offen offset:0 lds
  s_add_u32 s71, s72, 3072
  buffer_load_dwordx4 v12, s[24:27], s71 offen offset:1024 lds
  s_add_u32 s71, s72, 6144
  buffer_load_dwordx4 v12, s[24:27], s71 offen offset:2048 lds
  s_add_u32 s71, s72, 9216
  buffer_load_dwordx4 v12, s[24:27], s71 offen offset:3072 lds
  s_add_u32 m0, s81, 32768
  s_add_u32 s70, s83, 163840
  buffer_load_dwordx4 v4, s[4:7], s70 offen offset:0 nt lds
  buffer_load_dwordx4 v5, s[4:7], s70 offen offset:1024 nt lds
  buffer_load_dwordx4 v6, s[4:7], s70 offen offset:2048 nt lds
  buffer_load_dwordx4 v7, s[4:7], s70 offen offset:3072 nt lds
  s_add_u32 m0, s81, 49152
  s_add_u32 s70, s83, 147456
  buffer_load_dwordx4 v2, s[8:11], s70 offen offset:0 nt lds
  buffer_load_dwordx4 v2, s[8:11], s70 offen offset:1024 nt lds
  buffer_load_dwordx4 v2, s[8:11], s70 offen offset:2048 nt lds
  buffer_load_dwordx4 v2, s[8:11], s70 offen offset:3072 nt lds
  s_waitcnt vmcnt(12)
  s_barrier
  ds_read_b128 v[64:67], v18 offset:0
  ds_read_b128 v[68:71], v18 offset:512
  ds_read_b128 v[72:75], v18 offset:1024
  ds_read_b128 v[76:79], v18 offset:1536
  ds_read_b128 v[80:83], v19 offset:0
  ds_read_b128 v[84:87], v19 offset:512
  ds_read_b128 v[88:91], v19 offset:1024
  ds_read_b128 v[92:95], v19 offset:1536
  s_waitcnt lgkmcnt(0)
  v_readfirstlane_b32 s70, v24
  s_nop 0
  s_and_b32 s70, s70, 0x01010101
  s_cmp_eq_u32 s70, 0x01010101
  s_cbranch_scc0 B_slow0
B_slow0r:
  v_readfirstlane_b32 s69, v25
  s_nop 0
  s_add_u32 s69, s69, 1
  s_mul_i32 s70, s69, 0x9E3779B1
  s_and_b32 s82, s70, 0xff
  s_bfe_u32 s84, s70, 0x80008
  s_bfe_u32 s78, s70, 0x80010
  s_lshr_b32 s80, s70, 24
  s_or_b32 s84, s84, 1
  s_xor_b32 s84, s84, s82
  ds_read_b64_tr_b16 v[32:33], v8 offset:49152
  ds_read_b64_tr_b16 v[34:35], v8 offset:50176
  ds_read_b64_tr_b16 v[36:37], v9 offset:49152
  ds_read_b64_tr_b16 v[38:39], v9 offset:50176
  ds_read_b64_tr_b16 v[40:41], v10 offset:49152
  ds_read_b64_tr_b16 v[42:43], v10 offset:50176
  ds_read_b64_tr_b16 v[44:45], v11 offset:49152
  ds_read_b64_tr_b16 v[46:47], v11 offset:50176
  ds_read_b64_tr_b16 v[48:49], v8 offset:51200
  ds_read_b64_tr_b16 v[50:51], v8 offset:52224
  ds_read_b64_tr_b16 v[52:53], v9 offset:51200
  ds_read_b64_tr_b16 v[54:55], v9 offset:52224
  s_waitcnt lgkmcnt(8)
  v_mfma_f32_32x32x16_bf16 v[192:207], v[32:35], v[64:67], 0
  ds_read_b64_tr_b16 v[56:57], v10 offset:51200
  ds_read_b64_tr_b16 v[58:59], v10 offset:52224
  s_add_u32 s72, s58, s76
  s_mov_b64 exec, s[88:89]
  buffer_store_dwordx4 v[64:67], v13, s[20:23], s72 offen offset:0 sc1
  buffer_store_dwordx4 v[68:71], v13, s[20:23], s72 offen offset:1792 sc1
  s_mov_b64 exec, -1
  v_mfma_f32_32x32x16_bf16 v[208:223], v[36:39], v[64:67], 0
  ds_read_b64_tr_b16 v[60:61], v11 offset:51200
  ds_read_b64_tr_b16 v[62:63], v11 offset:52224
  s_add_u32 s72, s58, s76
  s_mov_b64 exec, s[88:89]
  buffer_store_dwordx4 v[72:75], v16, s[20:23], s72 offen offset:0 sc1
  buffer_store_dwordx4 v[76:79], v16, s[20:23], s72 offen offset:1792 sc1
  s_mov_b64 exec, -1
  s_waitcnt lgkmcnt(8)
  v_mfma_f32_32x32x16_bf16 v[224:239], v[40:43], v[64:67], 0
  ds_read_b64_tr_b16 v[32:33], v8 offset:53248
  ds_read_b64_tr_b16 v[34:35], v8 offset:54272
  s_add_u32 s72, s58, s3
  s_mov_b64 exec, s[88:89]
  buffer_store_dwordx4 v[80:83], v13, s[20:23], s72 offen offset:0 sc1
  buffer_store_dwordx4 v[84:87], v13, s[20:23], s72 offen offset:1792 sc1
  s_mov_b64 exec, -1
  v_mfma_f32_32x32x16_bf16 v[240:255], v[44:47], v[64:67], 0
  ds_read_b64_tr_b16 v[36:37], v9 offset:53248
  ds_read_b64_tr_b16 v[38:39], v9 offset:54272
  s_waitcnt lgkmcnt(8)
  v_mfma_f32_32x32x16_bf16 v[192:207], v[48:51], v[68:71], v[192:207]
  ds_read_b64_tr_b16 v[40:41], v10 offset:53248
  ds_read_b64_tr_b16 v[42:43], v10 offset:54272
  s_add_u32 s72, s58, s3
  s_mov_b64 exec, s[88:89]
  buffer_store_dwordx4 v[88:91], v16, s[20:23], s72 offen offset:0 sc1
  buffer_store_dwordx4 v[92:95], v16, s[20:23], s72 offen offset:1792 sc1
  s_mov_b64 exec, -1
  v_mfma_f32_32x32x16_bf16 v[208:223], v[52:55], v[68:71], v[208:223]
  ds_read_b64_tr_b16 v[44:45], v11 offset:53248
  ds_read_b64_tr_b16 v[46:47], v11 offset:54272
  s_add_u32 m0, s81, 65536
  s_add_u32 s70, s83, 180224
  buffer_load_dwordx4 v4, s[4:7], s70 offen offset:0 nt lds
  s_waitcnt lgkmcnt(8)
  v_mfma_f32_32x32x16_bf16 v[224:239], v[56:59], v[68:71], v[224:239]
  ds_read_b64_tr_b16 v[48:49], v8 offset:55296
  ds_read_b64_tr_b16 v[50:51], v8 offset:56320
  buffer_load_dwordx4 v5, s[4:7], s70 offen offset:1024 nt lds
  v_mfma_f32_32x32x16_bf16 v[240:255], v[60:63], v[68:71], v[240:255]
  ds_read_b64_tr_b16 v[52:53], v9 offset:55296
  ds_read_b64_tr_b16 v[54:55], v9 offset:56320
  s_waitcnt lgkmcnt(8)
  v_mfma_f32_32x32x16_bf16 v[192:207], v[32:35], v[72:75], v[192:207]
  ds_read_b64_tr_b16 v[56:57], v10 offset:55296
  ds_read_b64_tr_b16 v[58:59], v10 offset:56320
  buffer_load_dwordx4 v6, s[4:7], s70 offen offset:2048 nt lds
  v_mfma_f32_32x32x16_bf16 v[208:223], v[36:39], v[72:75], v[208:223]
  ds_read_b64_tr_b16 v[60:61], v11 offset:55296
  ds_read_b64_tr_b16 v[62:63], v11 offset:56320
  buffer_load_dwordx4 v7, s[4:7], s70 offen offset:3072 nt lds
  s_waitcnt lgkmcnt(8)
  v_mfma_f32_32x32x16_bf16 v[224:239], v[40:43], v[72:75], v[224:239]
  s_add_u32 m0, s81, 81920
  s_add_u32 s70, s83, 163840
  buffer_load_dwordx4 v2, s[8:11], s70 offen offset:0 nt lds
  v_mfma_f32_32x32x16_bf16 v[240:255], v[44:47], v[72:75], v[240:255]
  s_waitcnt lgkmcnt(4)
  v_mfma_f32_32x32x16_bf16 v[192:207], v[48:51], v[76:79], v[192:207]
  buffer_load_dwordx4 v2, s[8:11], s70 offen offset:1024 nt lds
  v_mfma_f32_32x32x16_bf16 v[208:223], v[52:55], v[76:79], v[208:223]
  buffer_load_dwordx4 v2, s[8:11], s70 offen offset:2048 nt lds
  s_waitcnt lgkmcnt(0)
  v_mfma_f32_32x32x16_bf16 v[224:239], v[56:59], v[76:79], v[224:239]
  buffer_load_dwordx4 v2, s[8:11], s70 offen offset:3072 nt lds
  v_mfma_f32_32x32x16_bf16 v[240:255], v[60:63], v[76:79], v[240:255]
  s_waitcnt vmcnt(8)
  s_barrier
  s_lshl_b32 s70, s86, 7
  s_lshl_b32 s71, s63, 2
  s_add_u32 s71, s71, 33554464
  s_add_u32 s70, s70, s71
  v_mov_b32 v28, 1
  s_mov_b64 exec, 1
  buffer_store_dword v28, off, s[20:23], s70 sc1
  s_mov_b64 exec, -1
  ds_read_b64_tr_b16 v[32:33], v8 offset:0
  ds_read_b64_tr_b16 v[34:35], v8 offset:1024
  ds_read_b64_tr_b16 v[36:37], v9 offset:0
  ds_read_b64_tr_b16 v[38:39], v9 offset:1024
  ds_read_b64_tr_b16 v[40:41], v10 offset:0
  ds_read_b64_tr_b16 v[42:43], v10 offset:1024
  ds_read_b64_tr_b16 v[44:45], v11 offset:0
  ds_read_b64_tr_b16 v[46:47], v11 offset:1024
  ds_read_b64_tr_b16 v[48:49], v8 offset:2048
  ds_read_b64_tr_b16 v[50:51], v8 offset:3072
  ds_read_b64_tr_b16 v[52:53], v9 offset:2048
  ds_read_b64_tr_b16 v[54:55], v9 offset:3072
  s_waitcnt lgkmcnt(8)
  v_mfma_f32_32x32x16_bf16 v[192:207], v[32:35], v[80:83], v[192:207]
  ds_read_b64_tr_b16 v[56:57], v10 offset:2048
  ds_read_b64_tr_b16 v[58:59], v10 offset:3072
  s_add_u32 m0, s81, 114688
  s_add_u32 s72, s55, s79
  s_add_u32 s71, s72, 0
  buffer_load_dwordx4 v12, s[24:27], s71 offen offset:0 lds
  v_mfma_f32_32x32x16_bf16 v[208:223], v[36:39], v[80:83], v[208:223]
  ds_read_b64_tr_b16 v[60:61], v11 offset:2048
  ds_read_b64_tr_b16 v[62:63], v11 offset:3072
  s_add_u32 s71, s72, 3072
  buffer_load_dwordx4 v12, s[24:27], s71 offen offset:1024 lds
  s_waitcnt lgkmcnt(8)
  v_mfma_f32_32x32x16_bf16 v[224:239], v[40:43], v[80:83], v[224:239]
  ds_read_b64_tr_b16 v[32:33], v8 offset:4096
  ds_read_b64_tr_b16 v[34:35], v8 offset:5120
  s_add_u32 s71, s72, 6144
  buffer_load_dwordx4 v12, s[24:27], s71 offen offset:2048 lds
  v_mfma_f32_32x32x16_bf16 v[240:255], v[44:47], v[80:83], v[240:255]
  ds_read_b64_tr_b16 v[36:37], v9 offset:4096
  ds_read_b64_tr_b16 v[38:39], v9 offset:5120
  s_waitcnt lgkmcnt(8)
  v_mfma_f32_32x32x16_bf16 v[192:207], v[48:51], v[84:87], v[192:207]
  ds_read_b64_tr_b16 v[40:41], v10 offset:4096
  ds_read_b64_tr_b16 v[42:43], v10 offset:5120
  s_add_u32 s71, s72, 9216
  buffer_load_dwordx4 v12, s[24:27], s71 offen offset:3072 lds
  v_mfma_f32_32x32x16_bf16 v[208:223], v[52:55], v[84:87], v[208:223]
  ds_read_b64_tr_b16 v[44:45], v11 offset:4096
  ds_read_b64_tr_b16 v[46:47], v11 offset:5120
  s_add_u32 m0, s81, 0
  s_add_u32 s70, s83, 196608
  buffer_load_dwordx4 v4, s[4:7], s70 offen offset:0 nt lds
  s_waitcnt lgkmcnt(8)
  v_mfma_f32_32x32x16_bf16 v[224:239], v[56:59], v[84:87], v[224:239]
  ds_read_b64_tr_b16 v[48:49], v8 offset:6144
  ds_read_b64_tr_b16 v[50:51], v8 offset:7168
  buffer_load_dwordx4 v5, s[4:7], s70 offen offset:1024 nt lds
  v_mfma_f32_32x32x16_bf16 v[240:255], v[60:63], v[84:87], v[240:255]
  ds_read_b64_tr_b16 v[52:53], v9 offset:6144
  ds_read_b64_tr_b16 v[54:55], v9 offset:7168
  s_waitcnt lgkmcnt(8)
  v_mfma_f32_32x32x16_bf16 v[192:207], v[32:35], v[88:91], v[192:207]
  ds_read_b64_tr_b16 v[56:57], v10 offset:6144
  ds_read_b64_tr_b16 v[58:59], v10 offset:7168
  buffer_load_dwordx4 v6, s[4:7], s70 offen offset:2048 nt lds
  v_mfma_f32_32x32x16_bf16 v[208:223], v[36:39], v[88:91], v[208:223]
  ds_read_b64_tr_b16 v[60:61], v11 offset:6144
  ds_read_b64_tr_b16 v[62:63], v11 offset:7168
  buffer_load_dwordx4 v7, s[4:7], s70 offen offset:3072 nt lds
  s_waitcnt lgkmcnt(8)
  v_mfma_f32_32x32x16_bf16 v[224:239], v[40:43], v[88:91], v[224:239]
  s_add_u32 m0, s81, 16384
  s_add_u32 s70, s83, 180224
  buffer_load_dwordx4 v2, s[8:11], s70 offen offset:0 nt lds
  v_mfma_f32_32x32x16_bf16 v[240:255], v[44:47], v[88:91], v[240:255]
  s_waitcnt lgkmcnt(4)
  v_mfma_f32_32x32x16_bf16 v[192:207], v[48:51], v[92:95], v[192:207]
  buffer_load_dwordx4 v2, s[8:11], s70 offen offset:1024 nt lds
  v_mfma_f32_32x32x16_bf16 v[208:223], v[52:55], v[92:95], v[208:223]
  buffer_load_dwordx4 v2, s[8:11], s70 offen offset:2048 nt lds
  s_waitcnt lgkmcnt(0)
  v_mfma_f32_32x32x16_bf16 v[224:239], v[56:59], v[92:95], v[224:239]
  buffer_load_dwordx4 v2, s[8:11], s70 offen offset:3072 nt lds
  v_mfma_f32_32x32x16_bf16 v[240:255], v[60:63], v[92:95], v[240:255]
  s_waitcnt vmcnt(13)
  s_barrier
  s_add_u32 m0, s81, 98304
  s_add_u32 s72, s55, s77
  s_add_u32 s71, s72, 0
  buffer_load_dwordx4 v12, s[24:27], s71 offen offset:0 lds
  s_add_u32 s71, s72, 3072
  buffer_load_dwordx4 v12, s[24:27], s71 offen offset:1024 lds
  s_add_u32 s71, s72, 6144
  buffer_load_dwordx4 v12, s[24:27], s71 offen offset:2048 lds
  s_add_u32 s71, s72, 9216
  buffer_load_dwordx4 v12, s[24:27], s71 offen offset:3072 lds
  s_add_u32 m0, s81, 32768
  s_add_u32 s70, s83, 212992
  buffer_load_dwordx4 v4, s[4:7], s70 offen offset:0 nt lds
  buffer_load_dwordx4 v5, s[4:7], s70 offen offset:1024 nt lds
  buffer_load_dwordx4 v6, s[4:7], s70 offen offset:2048 nt lds
  buffer_load_dwordx4 v7, s[4:7], s70 offen offset:3072 nt lds
  s_add_u32 m0, s81, 49152
  s_add_u32 s70, s83, 196608
  buffer_load_dwordx4 v2, s[8:11], s70 offen offset:0 nt lds
  buffer_load_dwordx4 v2, s[8:11], s70 offen offset:1024 nt lds
  buffer_load_dwordx4 v2, s[8:11], s70 offen offset:2048 nt lds
  buffer_load_dwordx4 v2, s[8:11], s70 offen offset:3072 nt lds
  s_waitcnt vmcnt(12)
  s_barrier
  s_add_u32 m0, s81, 131072
  s_add_u32 s72, s56, s77
  s_add_u32 s71, s72, 0
  buffer_load_dwordx4 v12, s[24:27], s71 offen offset:0 lds
  s_add_u32 s71, s72, 3072
  buffer_load_dwordx4 v12, s[24:27], s71 offen offset:1024 lds
  s_add_u32 s71, s72, 6144
  buffer_load_dwordx4 v12, s[24:27], s71 offen offset:2048 lds
  s_add_u32 s71, s72, 9216
  buffer_load_dwordx4 v12, s[24:27], s71 offen offset:3072 lds
  s_add_u32 m0, s81, 65536
  s_add_u32 s70, s83, 229376
  buffer_load_dwordx4 v4, s[4:7], s70 offen offset:0 nt lds
  buffer_load_dwordx4 v5, s[4:7], s70 offen offset:1024 nt lds
  buffer_load_dwordx4 v6, s[4:7], s70 offen offset:2048 nt lds
  buffer_load_dwordx4 v7, s[4:7], s70 offen offset:3072 nt lds
  s_add_u32 m0, s81, 81920
  s_add_u32 s70, s83, 212992
  buffer_load_dwordx4 v2, s[8:11], s70 offen offset:0 nt lds
  buffer_load_dwordx4 v2, s[8:11], s70 offen offset:1024 nt lds
  buffer_load_dwordx4 v2, s[8:11], s70 offen offset:2048 nt lds
  buffer_load_dwordx4 v2, s[8:11], s70 offen offset:3072 nt lds
  s_waitcnt vmcnt(12)
  s_barrier
  s_lshl_b32 s72, s63, 2
  s_add_u32 s72, s72, 33554464
  s_mov_b64 exec, 7
  buffer_load_dword v20, v21, s[20:23], s72 offen sc1
  s_mov_b64 exec, -1
  s_add_u32 m0, s81, 147456
  s_add_u32 s72, s56, s79
  s_add_u32 s71, s72, 0
  buffer_load_dwordx4 v12, s[24:27], s71 offen offset:0 lds
  s_add_u32 s71, s72, 3072
  buffer_load_dwordx4 v12, s[24:27], s71 offen offset:1024 lds
  s_add_u32 s71, s72, 6144
  buffer_load_dwordx4 v12, s[24:27], s71 offen offset:2048 lds
  s_add_u32 s71, s72, 9216
  buffer_load_dwordx4 v12, s[24:27], s71 offen offset:3072 lds
  s_add_u32 m0, s81, 0
  s_add_u32 s70, s83, 245760
  buffer_load_dwordx4 v4, s[4:7], s70 offen offset:0 nt lds
  buffer_load_dwordx4 v5, s[4:7], s70 offen offset:1024 nt lds
  buffer_load_dwordx4 v6, s[4:7], s70 offen offset:2048 nt lds
  buffer_load_dwordx4 v7, s[4:7], s70 offen offset:3072 nt lds
  s_add_u32 m0, s81, 16384
  s_add_u32 s70, s83, 229376
  buffer_load_dwordx4 v2, s[8:11], s70 offen offset:0 nt lds
  buffer_load_dwordx4 v2, s[8:11], s70 offen offset:1024 nt lds
  buffer_load_dwordx4 v2, s[8:11], s70 offen offset:2048 nt lds
  buffer_load_dwordx4 v2, s[8:11], s70 offen offset:3072 nt lds
  s_waitcnt vmcnt(12)
  s_barrier
  s_mov_b64 exec, 7
  v_cmp_ne_u32 vcc, 0, v20
  s_mov_b64 exec, -1
  s_cmp_eq_u32 vcc_lo, 7
  s_cbranch_scc0 B_slow1
B_slow1r:
  s_add_u32 m0, s81, 32768
  s_add_u32 s72, s57, s77
  s_add_u32 s71, s72, 0
  buffer_load_dwordx4 v12, s[24:27], s71 offen offset:0 lds
  s_add_u32 s71, s72, 3072
  buffer_load_dwordx4 v12, s[24:27], s71 offen offset:1024 lds
  s_add_u32 s71, s72, 6144
  buffer_load_dwordx4 v12, s[24:27], s71 offen offset:2048 lds
  s_add_u32 s71, s72, 9216
  buffer_load_dwordx4 v12, s[24:27], s71 offen offset:3072 lds
  s_add_u32 m0, s81, 49152
  s_add_u32 s70, s83, 245760
  buffer_load_dwordx4 v2, s[8:11], s70 offen offset:0 nt lds
  buffer_load_dwordx4 v2, s[8:11], s70 offen offset:1024 nt lds
  buffer_load_dwordx4 v2, s[8:11], s70 offen offset:2048 nt lds
  buffer_load_dwordx4 v2, s[8:11], s70 offen offset:3072 nt lds
  s_waitcnt vmcnt(8)
  s_barrier
  s_add_u32 m0, s81, 65536
  s_add_u32 s72, s57, s79
  s_add_u32 s71, s72, 0
  buffer_load_dwordx4 v12, s[24:27], s71 offen offset:0 lds
  s_add_u32 s71, s72, 3072
  buffer_load_dwordx4 v12, s[24:27], s71 offen offset:1024 lds
  s_add_u32 s71, s72, 6144
  buffer_load_dwordx4 v12, s[24:27], s71 offen offset:2048 lds
  s_add_u32 s71, s72, 9216
  buffer_load_dwordx4 v12, s[24:27], s71 offen offset:3072 lds
  s_add_u32 m0, s81, 81920
  s_add_u32 s72, s54, s77
  s_add_u32 s71, s72, 131072
  buffer_load_dwordx4 v12, s[24:27], s71 offen offset:0 lds
  s_add_u32 s71, s72, 134144
  buffer_load_dwordx4 v12, s[24:27], s71 offen offset:1024 lds
  s_add_u32 s71, s72, 137216
  buffer_load_dwordx4 v12, s[24:27], s71 offen offset:2048 lds
  s_add_u32 s71, s72, 140288
  buffer_load_dwordx4 v12, s[24:27], s71 offen offset:3072 lds
  s_add_u32 s72, s59, s76
  s_mov_b64 exec, s[88:89]
  buffer_load_dwordx4 v[96:99], v13, s[20:23], s72 offen offset:0 sc1
  buffer_load_dwordx4 v[100:103], v13, s[20:23], s72 offen offset:1792 sc1
  s_mov_b64 exec, -1
  s_add_u32 s72, s59, s76
  s_mov_b64 exec, s[88:89]
  buffer_load_dwordx4 v[104:107], v16, s[20:23], s72 offen offset:0 sc1
  buffer_load_dwordx4 v[108:111], v16, s[20:23], s72 offen offset:1792 sc1
  s_mov_b64 exec, -1
  s_add_u32 s72, s59, s3
  s_mov_b64 exec, s[88:89]
  buffer_load_dwordx4 v[112:115], v13, s[20:23], s72 offen offset:0 sc1
  buffer_load_dwordx4 v[116:119], v13, s[20:23], s72 offen offset:1792 sc1
  s_mov_b64 exec, -1
  s_add_u32 s72, s59, s3
  s_mov_b64 exec, s[88:89]
  buffer_load_dwordx4 v[120:123], v16, s[20:23], s72 offen offset:0 sc1
  buffer_load_dwordx4 v[124:127], v16, s[20:23], s72 offen offset:1792 sc1
  s_mov_b64 exec, -1
  s_waitcnt vmcnt(16)
  s_barrier
  s_waitcnt vmcnt(0)
  v_add_u32 v18, 0xfffe4000, v18
  v_add_u32 v19, 0xfffe4000, v19
  ds_read_b64_tr_b16 v[32:33], v8 offset:0
  ds_read_b64_tr_b16 v[34:35], v8 offset:1024
  ds_read_b64_tr_b16 v[36:37], v9 offset:0
  ds_read_b64_tr_b16 v[38:39], v9 offset:1024
  ds_read_b64_tr_b16 v[40:41], v10 offset:0
  ds_read_b64_tr_b16 v[42:43], v10 offset:1024
  ds_read_b64_tr_b16 v[44:45], v11 offset:0
  ds_read_b64_tr_b16 v[46:47], v11 offset:1024
  ds_read_b64_tr_b16 v[48:49], v8 offset:2048
  ds_read_b64_tr_b16 v[50:51], v8 offset:3072
  ds_read_b64_tr_b16 v[52:53], v9 offset:2048
  ds_read_b64_tr_b16 v[54:55], v9 offset:3072
  s_waitcnt lgkmcnt(8)
  v_mfma_f32_32x32x16_bf16 v[192:207], v[32:35], v[96:99], v[192:207]
  ds_read_b64_tr_b16 v[56:57], v10 offset:2048
  ds_read_b64_tr_b16 v[58:59], v10 offset:3072
  s_add_u32 s72, s60, s76
  s_mov_b64 exec, s[88:89]
  buffer_load_dwordx4 v[128:131], v13, s[20:23], s72 offen offset:0 sc1
  buffer_load_dwordx4 v[132:135], v13, s[20:23], s72 offen offset:1792 sc1
  s_mov_b64 exec, -1
  v_mfma_f32_32x32x16_bf16 v[208:223], v[36:39], v[96:99], v[208:223]
  ds_read_b64_tr_b16 v[60:61], v11 offset:2048
  ds_read_b64_tr_b16 v[62:63], v11 offset:3072
  s_waitcnt lgkmcnt(8)
  v_mfma_f32_32x32x16_bf16 v[224:239], v[40:43], v[96:99], v[224:239]
  ds_read_b64_tr_b16 v[32:33], v8 offset:4096
  ds_read_b64_tr_b16 v[34:35], v8 offset:5120
  v_mfma_f32_32x32x16_bf16 v[240:255], v[44:47], v[96:99], v[240:255]
  ds_read_b64_tr_b16 v[36:37], v9 offset:4096
  ds_read_b64_tr_b16 v[38:39], v9 offset:5120
  s_add_u32 s72, s60, s76
  s_mov_b64 exec, s[88:89]
  buffer_load_dwordx4 v[136:139], v16, s[20:23], s72 offen offset:0 sc1
  buffer_load_dwordx4 v[140:143], v16, s[20:23], s72 offen offset:1792 sc1
  s_mov_b64 exec, -1
  s_waitcnt lgkmcnt(8)
  v_mfma_f32_32x32x16_bf16 v[192:207], v[48:51], v[100:103], v[192:207]
  ds_read_b64_tr_b16 v[40:41], v10 offset:4096
  ds_read_b64_tr_b16 v[42:43], v10 offset:5120
  v_mfma_f32_32x32x16_bf16 v[208:223], v[52:55], v[100:103], v[208:223]
  ds_read_b64_tr_b16 v[44:45], v11 offset:4096
  ds_read_b64_tr_b16 v[46:47], v11 offset:5120
  s_waitcnt lgkmcnt(8)
  v_mfma_f32_32x32x16_bf16 v[224:239], v[56:59], v[100:103], v[224:239]
  ds_read_b64_tr_b16 v[48:49], v8 offset:6144
  ds_read_b64_tr_b16 v[50:51], v8 offset:7168
  s_add_u32 s72, s60, s3
  s_mov_b64 exec, s[88:89]
  buffer_load_dwordx4 v[144:147], v13, s[20:23], s72 offen offset:0 sc1
  buffer_load_dwordx4 v[148:151], v13, s[20:23], s72 offen offset:1792 sc1
  s_mov_b64 exec, -1
  v_mfma_f32_32x32x16_bf16 v[240:255], v[60:63], v[100:103], v[240:255]
  ds_read_b64_tr_b16 v[52:53], v9 offset:6144
  ds_read_b64_tr_b16 v[54:55], v9 offset:7168
  s_waitcnt lgkmcnt(8)
  v_mfma_f32_32x32x16_bf16 v[192:207], v[32:35], v[104:107], v[192:207]
  ds_read_b64_tr_b16 v[56:57], v10 offset:6144
  ds_read_b64_tr_b16 v[58:59], v10 offset:7168
  v_mfma_f32_32x32x16_bf16 v[208:223], v[36:39], v[104:107], v[208:223]
  ds_read_b64_tr_b16 v[60:61], v11 offset:6144
  ds_read_b64_tr_b16 v[62:63], v11 offset:7168
  s_add_u32 s72, s60, s3
  s_mov_b64 exec, s[88:89]
  buffer_load_dwordx4 v[152:155], v16, s[20:23], s72 offen offset:0 sc1
  buffer_load_dwordx4 v[156:159], v16, s[20:23], s72 offen offset:1792 sc1
  s_mov_b64 exec, -1
  s_waitcnt lgkmcnt(8)
  v_mfma_f32_32x32x16_bf16 v[224:239], v[40:43], v[104:107], v[224:239]
  ds_read_b64_tr_b16 v[32:33], v8 offset:16384
  ds_read_b64_tr_b16 v[34:35], v8 offset:17408
  v_mfma_f32_32x32x16_bf16 v[240:255], v[44:47], v[104:107], v[240:255]
  ds_read_b64_tr_b16 v[36:37], v9 offset:16384
  ds_read_b64_tr_b16 v[38:39], v9 offset:17408
  s_waitcnt lgkmcnt(8)
  v_mfma_f32_32x32x16_bf16 v[192:207], v[48:51], v[108:111], v[192:207]
  ds_read_b64_tr_b16 v[40:41], v10 offset:16384
  ds_read_b64_tr_b16 v[42:43], v10 offset:17408
  s_add_u32 s72, s61, s76
  s_mov_b64 exec, s[88:89]
  buffer_load_dwordx4 v[160:163], v13, s[20:23], s72 offen offset:0 sc1
  buffer_load_dwordx4 v[164:167], v13, s[20:23], s72 offen offset:1792 sc1
  s_mov_b64 exec, -1
  v_mfma_f32_32x32x16_bf16 v[208:223], v[52:55], v[108:111], v[208:223]
  ds_read_b64_tr_b16 v[44:45], v11 offset:16384
  ds_read_b64_tr_b16 v[46:47], v11 offset:17408
  s_waitcnt lgkmcnt(8)
  v_mfma_f32_32x32x16_bf16 v[224:239], v[56:59], v[108:111], v[224:239]
  ds_read_b64_tr_b16 v[48:49], v8 offset:18432
  ds_read_b64_tr_b16 v[50:51], v8 offset:19456
  v_mfma_f32_32x32x16_bf16 v[240:255], v[60:63], v[108:111], v[240:255]
  ds_read_b64_tr_b16 v[52:53], v9 offset:18432
  ds_read_b64_tr_b16 v[54:55], v9 offset:19456
  s_add_u32 s72, s61, s76
  s_mov_b64 exec, s[88:89]
  buffer_load_dwordx4 v[168:171], v16, s[20:23], s72 offen offset:0 sc1
  buffer_load_dwordx4 v[172:175], v16, s[20:23], s72 offen offset:1792 sc1
  s_mov_b64 exec, -1
  s_waitcnt lgkmcnt(8)
  v_mfma_f32_32x32x16_bf16 v[192:207], v[32:35], v[112:115], v[192:207]
  ds_read_b64_tr_b16 v[56:57], v10 offset:18432
  ds_read_b64_tr_b16 v[58:59], v10 offset:19456
  v_mfma_f32_32x32x16_bf16 v[208:223], v[36:39], v[112:115], v[208:223]
  ds_read_b64_tr_b16 v[60:61], v11 offset:18432
  ds_read_b64_tr_b16 v[62:63], v11 offset:19456
  s_waitcnt lgkmcnt(8)
  v_mfma_f32_32x32x16_bf16 v[224:239], v[40:43], v[112:115], v[224:239]
  ds_read_b64_tr_b16 v[32:33], v8 offset:20480
  ds_read_b64_tr_b16 v[34:35], v8 offset:21504
  s_add_u32 s72, s61, s3
  s_mov_b64 exec, s[88:89]
  buffer_load_dwordx4 v[176:179], v13, s[20:23], s72 offen offset:0 sc1
  buffer_load_dwordx4 v[180:183], v13, s[20:23], s72 offen offset:1792 sc1
  s_mov_b64 exec, -1
  v_mfma_f32_32x32x16_bf16 v[240:255], v[44:47], v[112:115], v[240:255]
  ds_read_b64_tr_b16 v[36:37], v9 offset:20480
  ds_read_b64_tr_b16 v[38:39], v9 offset:21504
  s_waitcnt lgkmcnt(8)
  v_mfma_f32_32x32x16_bf16 v[192:207], v[48:51], v[116:119], v[192:207]
  ds_read_b64_tr_b16 v[40:41], v10 offset:20480
  ds_read_b64_tr_b16 v[42:43], v10 offset:21504
  v_mfma_f32_32x32x16_bf16 v[208:223], v[52:55], v[116:119], v[208:223]
  ds_read_b64_tr_b16 v[44:45], v11 offset:20480
  ds_read_b64_tr_b16 v[46:47], v11 offset:21504
  s_add_u32 s72, s61, s3
  s_mov_b64 exec, s[88:89]
  buffer_load_dwordx4 v[184:187], v16, s[20:23], s72 offen offset:0 sc1
  buffer_load_dwordx4 v[188:191], v16, s[20:23], s72 offen offset:1792 sc1
  s_mov_b64 exec, -1
  s_waitcnt lgkmcnt(8)
  v_mfma_f32_32x32x16_bf16 v[224:239], v[56:59], v[116:119], v[224:239]
  ds_read_b64_tr_b16 v[48:49], v8 offset:22528
  ds_read_b64_tr_b16 v[50:51], v8 offset:23552
  v_mfma_f32_32x32x16_bf16 v[240:255], v[60:63], v[116:119], v[240:255]
  ds_read_b64_tr_b16 v[52:53], v9 offset:22528
  ds_read_b64_tr_b16 v[54:55], v9 offset:23552
  s_waitcnt lgkmcnt(8)
  v_mfma_f32_32x32x16_bf16 v[192:207], v[32:35], v[120:123], v[192:207]
  ds_read_b64_tr_b16 v[56:57], v10 offset:22528
  ds_read_b64_tr_b16 v[58:59], v10 offset:23552
  v_mfma_f32_32x32x16_bf16 v[208:223], v[36:39], v[120:123], v[208:223]
  ds_read_b64_tr_b16 v[60:61], v11 offset:22528
  ds_read_b64_tr_b16 v[62:63], v11 offset:23552
  s_waitcnt lgkmcnt(8)
  v_mfma_f32_32x32x16_bf16 v[224:239], v[40:43], v[120:123], v[224:239]
  ds_read_b64_tr_b16 v[32:33], v8 offset:32768
  ds_read_b64_tr_b16 v[34:35], v8 offset:33792
  v_mfma_f32_32x32x16_bf16 v[240:255], v[44:47], v[120:123], v[240:255]
  ds_read_b64_tr_b16 v[36:37], v9 offset:32768
  ds_read_b64_tr_b16 v[38:39], v9 offset:33792
  s_waitcnt lgkmcnt(8)
  v_mfma_f32_32x32x16_bf16 v[192:207], v[48:51], v[124:127], v[192:207]
  ds_read_b64_tr_b16 v[40:41], v10 offset:32768
  ds_read_b64_tr_b16 v[42:43], v10 offset:33792
  v_mfma_f32_32x32x16_bf16 v[208:223], v[52:55], v[124:127], v[208:223]
  ds_read_b64_tr_b16 v[44:45], v11 offset:32768
  ds_read_b64_tr_b16 v[46:47], v11 offset:33792
  s_waitcnt lgkmcnt(8)
  v_mfma_f32_32x32x16_bf16 v[224:239], v[56:59], v[124:127], v[224:239]
  ds_read_b64_tr_b16 v[48:49], v8 offset:34816
  ds_read_b64_tr_b16 v[50:51], v8 offset:35840
  v_mfma_f32_32x32x16_bf16 v[240:255], v[60:63], v[124:127], v[240:255]
  ds_read_b64_tr_b16 v[52:53], v9 offset:34816
  ds_read_b64_tr_b16 v[54:55], v9 offset:35840
  s_barrier
  s_waitcnt vmcnt(8)
  s_waitcnt lgkmcnt(8)
  v_mfma_f32_32x32x16_bf16 v[192:207], v[32:35], v[128:131], v[192:207]
  ds_read_b64_tr_b16 v[56:57], v10 offset:34816
  ds_read_b64_tr_b16 v[58:59], v10 offset:35840
  v_mfma_f32_32x32x16_bf16 v[208:223], v[36:39], v[128:131], v[208:223]
  ds_read_b64_tr_b16 v[60:61], v11 offset:34816
  ds_read_b64_tr_b16 v[62:63], v11 offset:35840
  s_waitcnt lgkmcnt(8)
  v_mfma_f32_32x32x16_bf16 v[224:239], v[40:43], v[128:131], v[224:239]
  ds_read_b64_tr_b16 v[32:33], v8 offset:36864
  ds_read_b64_tr_b16 v[34:35], v8 offset:37888
  v_mfma_f32_32x32x16_bf16 v[240:255], v[44:47], v[128:131], v[240:255]
  ds_read_b64_tr_b16 v[36:37], v9 offset:36864
  ds_read_b64_tr_b16 v[38:39], v9 offset:37888
  s_waitcnt lgkmcnt(8)
  v_mfma_f32_32x32x16_bf16 v[192:207], v[48:51], v[132:135], v[192:207]
  ds_read_b64_tr_b16 v[40:41], v10 offset:36864
  ds_read_b64_tr_b16 v[42:43], v10 offset:37888
  v_mfma_f32_32x32x16_bf16 v[208:223], v[52:55], v[132:135], v[208:223]
  ds_read_b64_tr_b16 v[44:45], v11 offset:36864
  ds_read_b64_tr_b16 v[46:47], v11 offset:37888
  s_waitcnt lgkmcnt(8)
  v_mfma_f32_32x32x16_bf16 v[224:239], v[56:59], v[132:135], v[224:239]
  ds_read_b64_tr_b16 v[48:49], v8 offset:38912
  ds_read_b64_tr_b16 v[50:51], v8 offset:39936
  v_mfma_f32_32x32x16_bf16 v[240:255], v[60:63], v[132:135], v[240:255]
  ds_read_b64_tr_b16 v[52:53], v9 offset:38912
  ds_read_b64_tr_b16 v[54:55], v9 offset:39936
  s_waitcnt lgkmcnt(8)
  v_mfma_f32_32x32x16_bf16 v[192:207], v[32:35], v[136:139], v[192:207]
  ds_read_b64_tr_b16 v[56:57], v10 offset:38912
  ds_read_b64_tr_b16 v[58:59], v10 offset:39936
  v_mfma_f32_32x32x16_bf16 v[208:223], v[36:39], v[136:139], v[208:223]
  ds_read_b64_tr_b16 v[60:61], v11 offset:38912
  ds_read_b64_tr_b16 v[62:63], v11 offset:39936
  s_waitcnt lgkmcnt(8)
  v_mfma_f32_32x32x16_bf16 v[224:239], v[40:43], v[136:139], v[224:239]
  ds_read_b64_tr_b16 v[32:33], v8 offset:49152
  ds_read_b64_tr_b16 v[34:35], v8 offset:50176
  v_mfma_f32_32x32x16_bf16 v[240:255], v[44:47], v[136:139], v[240:255]
  ds_read_b64_tr_b16 v[36:37], v9 offset:49152
  ds_read_b64_tr_b16 v[38:39], v9 offset:50176
  s_waitcnt lgkmcnt(8)
  v_mfma_f32_32x32x16_bf16 v[192:207], v[48:51], v[140:143], v[192:207]
  ds_read_b64_tr_b16 v[40:41], v10 offset:49152
  ds_read_b64_tr_b16 v[42:43], v10 offset:50176
  v_mfma_f32_32x32x16_bf16 v[208:223], v[52:55], v[140:143], v[208:223]
  ds_read_b64_tr_b16 v[44:45], v11 offset:49152
  ds_read_b64_tr_b16 v[46:47], v11 offset:50176
  s_waitcnt lgkmcnt(8)
  v_mfma_f32_32x32x16_bf16 v[224:239], v[56:59], v[140:143], v[224:239]
  ds_read_b64_tr_b16 v[48:49], v8 offset:51200
  ds_read_b64_tr_b16 v[50:51], v8 offset:52224
  v_mfma_f32_32x32x16_bf16 v[240:255], v[60:63], v[140:143], v[240:255]
  ds_read_b64_tr_b16 v[52:53], v9 offset:51200
  ds_read_b64_tr_b16 v[54:55], v9 offset:52224
  s_waitcnt lgkmcnt(8)
  v_mfma_f32_32x32x16_bf16 v[192:207], v[32:35], v[144:147], v[192:207]
  ds_read_b64_tr_b16 v[56:57], v10 offset:51200
  ds_read_b64_tr_b16 v[58:59], v10 offset:52224
  v_mfma_f32_32x32x16_bf16 v[208:223], v[36:39], v[144:147], v[208:223]
  ds_read_b64_tr_b16 v[60:61], v11 offset:51200
  ds_read_b64_tr_b16 v[62:63], v11 offset:52224
  s_waitcnt lgkmcnt(8)
  v_mfma_f32_32x32x16_bf16 v[224:239], v[40:43], v[144:147], v[224:239]
  ds_read_b64_tr_b16 v[32:33], v8 offset:53248
  ds_read_b64_tr_b16 v[34:35], v8 offset:54272
  v_mfma_f32_32x32x16_bf16 v[240:255], v[44:47], v[144:147], v[240:255]
  ds_read_b64_tr_b16 v[36:37], v9 offset:53248
  ds_read_b64_tr_b16 v[38:39], v9 offset:54272
  s_waitcnt lgkmcnt(8)
  v_mfma_f32_32x32x16_bf16 v[192:207], v[48:51], v[148:151], v[192:207]
  ds_read_b64_tr_b16 v[40:41], v10 offset:53248
  ds_read_b64_tr_b16 v[42:43], v10 offset:54272
  v_mfma_f32_32x32x16_bf16 v[208:223], v[52:55], v[148:151], v[208:223]
  ds_read_b64_tr_b16 v[44:45], v11 offset:53248
  ds_read_b64_tr_b16 v[46:47], v11 offset:54272
  s_waitcnt lgkmcnt(8)
  v_mfma_f32_32x32x16_bf16 v[224:239], v[56:59], v[148:151], v[224:239]
  ds_read_b64_tr_b16 v[48:49], v8 offset:55296
  ds_read_b64_tr_b16 v[50:51], v8 offset:56320
  v_mfma_f32_32x32x16_bf16 v[240:255], v[60:63], v[148:151], v[240:255]
  ds_read_b64_tr_b16 v[52:53], v9 offset:55296
  ds_read_b64_tr_b16 v[54:55], v9 offset:56320
  s_waitcnt lgkmcnt(8)
  v_mfma_f32_32x32x16_bf16 v[192:207], v[32:35], v[152:155], v[192:207]
  ds_read_b64_tr_b16 v[56:57], v10 offset:55296
  ds_read_b64_tr_b16 v[58:59], v10 offset:56320
  v_mfma_f32_32x32x16_bf16 v[208:223], v[36:39], v[152:155], v[208:223]
  ds_read_b64_tr_b16 v[60:61], v11 offset:55296
  ds_read_b64_tr_b16 v[62:63], v11 offset:56320
  s_waitcnt lgkmcnt(8)
  v_mfma_f32_32x32x16_bf16 v[224:239], v[40:43], v[152:155], v[224:239]
  v_add_u32 v8, 0xffff0000, v8
  v_add_u32 v9, 0xffff0000, v9
  v_add_u32 v10, 0xffff0000, v10
  v_add_u32 v11, 0xffff0000, v11
  ds_read_b64_tr_b16 v[32:33], v8 offset:0
  ds_read_b64_tr_b16 v[34:35], v8 offset:1024
  v_mfma_f32_32x32x16_bf16 v[240:255], v[44:47], v[152:155], v[240:255]
  ds_read_b64_tr_b16 v[36:37], v9 offset:0
  ds_read_b64_tr_b16 v[38:39], v9 offset:1024
  s_waitcnt lgkmcnt(8)
  v_mfma_f32_32x32x16_bf16 v[192:207], v[48:51], v[156:159], v[192:207]
  ds_read_b64_tr_b16 v[40:41], v10 offset:0
  ds_read_b64_tr_b16 v[42:43], v10 offset:1024
  v_mfma_f32_32x32x16_bf16 v[208:223], v[52:55], v[156:159], v[208:223]
  ds_read_b64_tr_b16 v[44:45], v11 offset:0
  ds_read_b64_tr_b16 v[46:47], v11 offset:1024
  s_waitcnt lgkmcnt(8)
  v_mfma_f32_32x32x16_bf16 v[224:239], v[56:59], v[156:159], v[224:239]
  ds_read_b64_tr_b16 v[48:49], v8 offset:2048
  ds_read_b64_tr_b16 v[50:51], v8 offset:3072
  v_mfma_f32_32x32x16_bf16 v[240:255], v[60:63], v[156:159], v[240:255]
  ds_read_b64_tr_b16 v[52:53], v9 offset:2048
  ds_read_b64_tr_b16 v[54:55], v9 offset:3072
  s_waitcnt vmcnt(0)
  s_barrier
  s_waitcnt lgkmcnt(8)
  v_mfma_f32_32x32x16_bf16 v[192:207], v[32:35], v[160:163], v[192:207]
  ds_read_b64_tr_b16 v[56:57], v10 offset:2048
  ds_read_b64_tr_b16 v[58:59], v10 offset:3072
  v_mfma_f32_32x32x16_bf16 v[208:223], v[36:39], v[160:163], v[208:223]
  ds_read_b64_tr_b16 v[60:61], v11 offset:2048
  ds_read_b64_tr_b16 v[62:63], v11 offset:3072
  s_waitcnt lgkmcnt(8)
  v_mfma_f32_32x32x16_bf16 v[224:239], v[40:43], v[160:163], v[224:239]
  ds_read_b64_tr_b16 v[32:33], v8 offset:4096
  ds_read_b64_tr_b16 v[34:35], v8 offset:5120
  v_mfma_f32_32x32x16_bf16 v[240:255], v[44:47], v[160:163], v[240:255]
  ds_read_b64_tr_b16 v[36:37], v9 offset:4096
  ds_read_b64_tr_b16 v[38:39], v9 offset:5120
  s_waitcnt lgkmcnt(8)
  v_mfma_f32_32x32x16_bf16 v[192:207], v[48:51], v[164:167], v[192:207]
  ds_read_b64_tr_b16 v[40:41], v10 offset:4096
  ds_read_b64_tr_b16 v[42:43], v10 offset:5120
  ds_read_b128 v[64:67], v18 offset:0
  v_mfma_f32_32x32x16_bf16 v[208:223], v[52:55], v[164:167], v[208:223]
  ds_read_b64_tr_b16 v[44:45], v11 offset:4096
  ds_read_b64_tr_b16 v[46:47], v11 offset:5120
  s_waitcnt lgkmcnt(8)
  v_mfma_f32_32x32x16_bf16 v[224:239], v[56:59], v[164:167], v[224:239]
  ds_read_b64_tr_b16 v[48:49], v8 offset:6144
  ds_read_b64_tr_b16 v[50:51], v8 offset:7168
  ds_read_b128 v[68:71], v18 offset:512
  v_mfma_f32_32x32x16_bf16 v[240:255], v[60:63], v[164:167], v[240:255]
  ds_read_b64_tr_b16 v[52:53], v9 offset:6144
  ds_read_b64_tr_b16 v[54:55], v9 offset:7168
  s_waitcnt lgkmcnt(8)
  v_mfma_f32_32x32x16_bf16 v[192:207], v[32:35], v[168:171], v[192:207]
  ds_read_b64_tr_b16 v[56:57], v10 offset:6144
  ds_read_b64_tr_b16 v[58:59], v10 offset:7168
  ds_read_b128 v[72:75], v18 offset:1024
  v_mfma_f32_32x32x16_bf16 v[208:223], v[36:39], v[168:171], v[208:223]
  ds_read_b64_tr_b16 v[60:61], v11 offset:6144
  ds_read_b64_tr_b16 v[62:63], v11 offset:7168
  s_waitcnt lgkmcnt(8)
  v_mfma_f32_32x32x16_bf16 v[224:239], v[40:43], v[168:171], v[224:239]
  ds_read_b64_tr_b16 v[32:33], v8 offset:32768
  ds_read_b64_tr_b16 v[34:35], v8 offset:33792
  ds_read_b128 v[76:79], v18 offset:1536
  v_mfma_f32_32x32x16_bf16 v[240:255], v[44:47], v[168:171], v[240:255]
  ds_read_b64_tr_b16 v[36:37], v9 offset:32768
  ds_read_b64_tr_b16 v[38:39], v9 offset:33792
  s_waitcnt lgkmcnt(8)
  v_mfma_f32_32x32x16_bf16 v[192:207], v[48:51], v[172:175], v[192:207]
  ds_read_b64_tr_b16 v[40:41], v10 offset:32768
  ds_read_b64_tr_b16 v[42:43], v10 offset:33792
  ds_read_b128 v[80:83], v19 offset:0
  v_mfma_f32_32x32x16_bf16 v[208:223], v[52:55], v[172:175], v[208:223]
  ds_read_b64_tr_b16 v[44:45], v11 offset:32768
  ds_read_b64_tr_b16 v[46:47], v11 offset:33792
  s_waitcnt lgkmcnt(8)
  v_mfma_f32_32x32x16_bf16 v[224:239], v[56:59], v[172:175], v[224:239]
  ds_read_b64_tr_b16 v[48:49], v8 offset:34816
  ds_read_b64_tr_b16 v[50:51], v8 offset:35840
  ds_read_b128 v[84:87], v19 offset:512
  v_mfma_f32_32x32x16_bf16 v[240:255], v[60:63], v[172:175], v[240:255]
  ds_read_b64_tr_b16 v[52:53], v9 offset:34816
  ds_read_b64_tr_b16 v[54:55], v9 offset:35840
  s_waitcnt lgkmcnt(8)
  v_mfma_f32_32x32x16_bf16 v[192:207], v[32:35], v[176:179], v[192:207]
  ds_read_b64_tr_b16 v[56:57], v10 offset:34816
  ds_read_b64_tr_b16 v[58:59], v10 offset:35840
  ds_read_b128 v[88:91], v19 offset:1024
  v_mfma_f32_32x32x16_bf16 v[208:223], v[36:39], v[176:179], v[208:223]
  ds_read_b64_tr_b16 v[60:61], v11 offset:34816
  ds_read_b64_tr_b16 v[62:63], v11 offset:35840
  s_waitcnt lgkmcnt(8)
  v_mfma_f32_32x32x16_bf16 v[224:239], v[40:43], v[176:179], v[224:239]
  ds_read_b64_tr_b16 v[32:33], v8 offset:36864
  ds_read_b64_tr_b16 v[34:35], v8 offset:37888
  ds_read_b128 v[92:95], v19 offset:1536
  v_mfma_f32_32x32x16_bf16 v[240:255], v[44:47], v[176:179], v[240:255]
  ds_read_b64_tr_b16 v[36:37], v9 offset:36864
  ds_read_b64_tr_b16 v[38:39], v9 offset:37888
  s_waitcnt lgkmcnt(8)
  v_mfma_f32_32x32x16_bf16 v[192:207], v[48:51], v[180:183], v[192:207]
  ds_read_b64_tr_b16 v[40:41], v10 offset:36864
  ds_read_b64_tr_b16 v[42:43], v10 offset:37888
  v_mfma_f32_32x32x16_bf16 v[208:223], v[52:55], v[180:183], v[208:223]
  ds_read_b64_tr_b16 v[44:45], v11 offset:36864
  ds_read_b64_tr_b16 v[46:47], v11 offset:37888
  s_waitcnt lgkmcnt(8)
  v_mfma_f32_32x32x16_bf16 v[224:239], v[56:59], v[180:183], v[224:239]
  ds_read_b64_tr_b16 v[48:49], v8 offset:38912
  ds_read_b64_tr_b16 v[50:51], v8 offset:39936
  v_mfma_f32_32x32x16_bf16 v[240:255], v[60:63], v[180:183], v[240:255]
  ds_read_b64_tr_b16 v[52:53], v9 offset:38912
  ds_read_b64_tr_b16 v[54:55], v9 offset:39936
  s_waitcnt lgkmcnt(8)
  v_mfma_f32_32x32x16_bf16 v[192:207], v[32:35], v[184:187], v[192:207]
  ds_read_b64_tr_b16 v[56:57], v10 offset:38912
  ds_read_b64_tr_b16 v[58:59], v10 offset:39936
  v_mfma_f32_32x32x16_bf16 v[208:223], v[36:39], v[184:187], v[208:223]
  ds_read_b64_tr_b16 v[60:61], v11 offset:38912
  ds_read_b64_tr_b16 v[62:63], v11 offset:39936
  s_waitcnt lgkmcnt(8)
  v_mfma_f32_32x32x16_bf16 v[224:239], v[40:43], v[184:187], v[224:239]
  ds_read_b64_tr_b16 v[32:33], v8 offset:49152
  ds_read_b64_tr_b16 v[34:35], v8 offset:50176
  v_mfma_f32_32x32x16_bf16 v[240:255], v[44:47], v[184:187], v[240:255]
  ds_read_b64_tr_b16 v[36:37], v9 offset:49152
  ds_read_b64_tr_b16 v[38:39], v9 offset:50176
  s_waitcnt lgkmcnt(8)
  v_mfma_f32_32x32x16_bf16 v[192:207], v[48:51], v[188:191], v[192:207]
  ds_read_b64_tr_b16 v[40:41], v10 offset:49152
  ds_read_b64_tr_b16 v[42:43], v10 offset:50176
  v_mfma_f32_32x32x16_bf16 v[208:223], v[52:55], v[188:191], v[208:223]
  ds_read_b64_tr_b16 v[44:45], v11 offset:49152
  ds_read_b64_tr_b16 v[46:47], v11 offset:50176
  s_waitcnt lgkmcnt(8)
  v_mfma_f32_32x32x16_bf16 v[224:239], v[56:59], v[188:191], v[224:239]
  ds_read_b64_tr_b16 v[48:49], v8 offset:51200
  ds_read_b64_tr_b16 v[50:51], v8 offset:52224
  v_mfma_f32_32x32x16_bf16 v[240:255], v[60:63], v[188:191], v[240:255]
  ds_read_b64_tr_b16 v[52:53], v9 offset:51200
  ds_read_b64_tr_b16 v[54:55], v9 offset:52224
  s_barrier
  s_waitcnt lgkmcnt(8)
  v_mfma_f32_32x32x16_bf16 v[192:207], v[32:35], v[64:67], v[192:207]
  ds_read_b64_tr_b16 v[56:57], v10 offset:51200
  ds_read_b64_tr_b16 v[58:59], v10 offset:52224
  v_mfma_f32_32x32x16_bf16 v[208:223], v[36:39], v[64:67], v[208:223]
  ds_read_b64_tr_b16 v[60:61], v11 offset:51200
  ds_read_b64_tr_b16 v[62:63], v11 offset:52224
  s_waitcnt lgkmcnt(8)
  v_mfma_f32_32x32x16_bf16 v[224:239], v[40:43], v[64:67], v[224:239]
  ds_read_b64_tr_b16 v[32:33], v8 offset:53248
  ds_read_b64_tr_b16 v[34:35], v8 offset:54272
  v_lshrrev_b32 v17, 5, v1
  v_mul_u32_u24 v23, 112, v17
  v_mfma_f32_32x32x16_bf16 v[240:255], v[44:47], v[64:67], v[240:255]
  ds_read_b64_tr_b16 v[36:37], v9 offset:53248
  ds_read_b64_tr_b16 v[38:39], v9 offset:54272
  v_and_b32 v18, 31, v1
  s_waitcnt lgkmcnt(8)
  v_mfma_f32_32x32x16_bf16 v[192:207], v[48:51], v[68:71], v[192:207]
  ds_read_b64_tr_b16 v[40:41], v10 offset:53248
  ds_read_b64_tr_b16 v[42:43], v10 offset:54272
  v_add_u32 v23, v23, v18
  v_mfma_f32_32x32x16_bf16 v[208:223], v[52:55], v[68:71], v[208:223]
  ds_read_b64_tr_b16 v[44:45], v11 offset:53248
  ds_read_b64_tr_b16 v[46:47], v11 offset:54272
  s_lshl_b32 s70, s63, 5
  s_waitcnt lgkmcnt(8)
  v_mfma_f32_32x32x16_bf16 v[224:239], v[56:59], v[68:71], v[224:239]
  ds_read_b64_tr_b16 v[48:49], v8 offset:55296
  ds_read_b64_tr_b16 v[50:51], v8 offset:56320
  v_add_u32 v23, s70, v23
  v_mfma_f32_32x32x16_bf16 v[240:255], v[60:63], v[68:71], v[240:255]
  ds_read_b64_tr_b16 v[52:53], v9 offset:55296
  ds_read_b64_tr_b16 v[54:55], v9 offset:56320
  v_add_u32 v19, s70, v18
  v_lshlrev_b32 v23, 4, v23
  s_waitcnt lgkmcnt(8)
  v_mfma_f32_32x32x16_bf16 v[192:207], v[32:35], v[72:75], v[192:207]
  ds_read_b64_tr_b16 v[56:57], v10 offset:55296
  ds_read_b64_tr_b16 v[58:59], v10 offset:56320
  s_lshl_b32 s70, s64, 3
  v_mfma_f32_32x32x16_bf16 v[208:223], v[36:39], v[72:75], v[208:223]
  ds_read_b64_tr_b16 v[60:61], v11 offset:55296
  ds_read_b64_tr_b16 v[62:63], v11 offset:56320
  s_add_u32 s70, s70, s66
  s_waitcnt lgkmcnt(8)
  v_mfma_f32_32x32x16_bf16 v[224:239], v[40:43], v[72:75], v[224:239]
  ds_read_b64_tr_b16 v[32:33], v8 offset:16384
  ds_read_b64_tr_b16 v[34:35], v8 offset:17408
  s_lshl_b32 s70, s70, 2
  v_mfma_f32_32x32x16_bf16 v[240:255], v[44:47], v[72:75], v[240:255]
  ds_read_b64_tr_b16 v[36:37], v9 offset:16384
  ds_read_b64_tr_b16 v[38:39], v9 offset:17408
  s_add_u32 s70, s70, s67
  s_waitcnt lgkmcnt(8)
  v_mfma_f32_32x32x16_bf16 v[192:207], v[48:51], v[76:79], v[192:207]
  ds_read_b64_tr_b16 v[40:41], v10 offset:16384
  ds_read_b64_tr_b16 v[42:43], v10 offset:17408
  s_mul_i32 s73, s70, 172032
  s_lshl_b32 s72, s63, 2
  s_add_u32 s72, s72, 33554432
  s_mov_b64 exec, 7
  buffer_load_dword v20, v21, s[20:23], s72 offen sc1
  s_mov_b64 exec, -1
  v_mfma_f32_32x32x16_bf16 v[208:223], v[52:55], v[76:79], v[208:223]
  ds_read_b64_tr_b16 v[44:45], v11 offset:16384
  ds_read_b64_tr_b16 v[46:47], v11 offset:17408
  s_add_u32 s73, s73, 16777216
  s_add_u32 s70, s65, 1
  s_waitcnt lgkmcnt(8)
  v_mfma_f32_32x32x16_bf16 v[224:239], v[56:59], v[76:79], v[224:239]
  ds_read_b64_tr_b16 v[48:49], v8 offset:18432
  ds_read_b64_tr_b16 v[50:51], v8 offset:19456
  s_and_b32 s70, s70, 3
  v_mfma_f32_32x32x16_bf16 v[240:255], v[60:63], v[76:79], v[240:255]
  ds_read_b64_tr_b16 v[52:53], v9 offset:18432
  ds_read_b64_tr_b16 v[54:55], v9 offset:19456
  s_mul_i32 s70, s70, 43008
  s_waitcnt lgkmcnt(8)
  v_mfma_f32_32x32x16_bf16 v[192:207], v[32:35], v[80:83], v[192:207]
  ds_read_b64_tr_b16 v[56:57], v10 offset:18432
  ds_read_b64_tr_b16 v[58:59], v10 offset:19456
  s_add_u32 s70, s70, s73
  v_mfma_f32_32x32x16_bf16 v[208:223], v[36:39], v[80:83], v[208:223]
  ds_read_b64_tr_b16 v[60:61], v11 offset:18432
  ds_read_b64_tr_b16 v[62:63], v11 offset:19456
  s_add_u32 s54, s70, 28672
  s_waitcnt lgkmcnt(8)
  v_mfma_f32_32x32x16_bf16 v[224:239], v[40:43], v[80:83], v[224:239]
  ds_read_b64_tr_b16 v[32:33], v8 offset:20480
  ds_read_b64_tr_b16 v[34:35], v8 offset:21504
  s_add_u32 s70, s65, 2
  s_and_b32 s70, s70, 3
  v_mfma_f32_32x32x16_bf16 v[240:255], v[44:47], v[80:83], v[240:255]
  ds_read_b64_tr_b16 v[36:37], v9 offset:20480
  ds_read_b64_tr_b16 v[38:39], v9 offset:21504
  s_mul_i32 s70, s70, 43008
  s_waitcnt lgkmcnt(8)
  v_mfma_f32_32x32x16_bf16 v[192:207], v[48:51], v[84:87], v[192:207]
  ds_read_b64_tr_b16 v[40:41], v10 offset:20480
  ds_read_b64_tr_b16 v[42:43], v10 offset:21504
  s_add_u32 s70, s70, s73
  v_mfma_f32_32x32x16_bf16 v[208:223], v[52:55], v[84:87], v[208:223]
  ds_read_b64_tr_b16 v[44:45], v11 offset:20480
  ds_read_b64_tr_b16 v[46:47], v11 offset:21504
  s_add_u32 s55, s70, 14336
  s_waitcnt lgkmcnt(8)
  v_mfma_f32_32x32x16_bf16 v[224:239], v[56:59], v[84:87], v[224:239]
  ds_read_b64_tr_b16 v[48:49], v8 offset:22528
  ds_read_b64_tr_b16 v[50:51], v8 offset:23552
  s_add_u32 s70, s65, 3
  v_mfma_f32_32x32x16_bf16 v[240:255], v[60:63], v[84:87], v[240:255]
  ds_read_b64_tr_b16 v[52:53], v9 offset:22528
  ds_read_b64_tr_b16 v[54:55], v9 offset:23552
  s_and_b32 s70, s70, 3
  s_waitcnt lgkmcnt(8)
  v_mfma_f32_32x32x16_bf16 v[192:207], v[32:35], v[88:91], v[192:207]
  ds_read_b64_tr_b16 v[56:57], v10 offset:22528
  ds_read_b64_tr_b16 v[58:59], v10 offset:23552
  s_mul_i32 s70, s70, 43008
  s_add_u32 s70, s70, s73
  v_mfma_f32_32x32x16_bf16 v[208:223], v[36:39], v[88:91], v[208:223]
  ds_read_b64_tr_b16 v[60:61], v11 offset:22528
  ds_read_b64_tr_b16 v[62:63], v11 offset:23552
  s_add_u32 s56, s70, 0
  s_waitcnt lgkmcnt(8)
  v_mfma_f32_32x32x16_bf16 v[224:239], v[40:43], v[88:91], v[224:239]
  v_lshlrev_b32 v19, 11, v19
  v_mfma_f32_32x32x16_bf16 v[240:255], v[44:47], v[88:91], v[240:255]
  v_lshlrev_b32 v17, 4, v17
  s_waitcnt lgkmcnt(4)
  v_mfma_f32_32x32x16_bf16 v[192:207], v[48:51], v[92:95], v[192:207]
  v_add_u32 v19, v19, v17
  v_mfma_f32_32x32x16_bf16 v[208:223], v[52:55], v[92:95], v[208:223]
  v_mov_b32 v24, 0xff
  s_waitcnt lgkmcnt(0)
  v_mfma_f32_32x32x16_bf16 v[224:239], v[56:59], v[92:95], v[224:239]
  v_mfma_f32_32x32x16_bf16 v[240:255], v[60:63], v[92:95], v[240:255]
  s_waitcnt vmcnt(0)
  s_mov_b64 exec, 7
  v_cmp_ne_u32 vcc, 0, v20
  s_mov_b64 exec, -1
  s_cmp_eq_u32 vcc_lo, 7
  s_cbranch_scc0 B_slow2
B_slow2r:
  s_add_u32 s72, s59, s76
  s_add_u32 s72, s72, 28672
  s_mov_b64 exec, s[88:89]
  buffer_load_dwordx4 v[96:99], v13, s[20:23], s72 offen offset:0 sc1
  buffer_load_dwordx4 v[100:103], v13, s[20:23], s72 offen offset:1792 sc1
  s_mov_b64 exec, -1
  s_add_u32 s72, s59, s76
  s_add_u32 s72, s72, 28672
  s_mov_b64 exec, s[88:89]
  buffer_load_dwordx4 v[104:107], v16, s[20:23], s72 offen offset:0 sc1
  buffer_load_dwordx4 v[108:111], v16, s[20:23], s72 offen offset:1792 sc1
  s_mov_b64 exec, -1
  s_add_u32 s72, s59, s3
  s_add_u32 s72, s72, 28672
  s_mov_b64 exec, s[88:89]
  buffer_load_dwordx4 v[112:115], v13, s[20:23], s72 offen offset:0 sc1
  buffer_load_dwordx4 v[116:119], v13, s[20:23], s72 offen offset:1792 sc1
  s_mov_b64 exec, -1
  s_add_u32 s72, s59, s3
  s_add_u32 s72, s72, 28672
  s_mov_b64 exec, s[88:89]
  buffer_load_dwordx4 v[120:123], v16, s[20:23], s72 offen offset:0 sc1
  buffer_load_dwordx4 v[124:127], v16, s[20:23], s72 offen offset:1792 sc1
  s_mov_b64 exec, -1
  s_add_u32 s72, s60, s76
  s_add_u32 s72, s72, 28672
  s_mov_b64 exec, s[88:89]
  buffer_load_dwordx4 v[128:131], v13, s[20:23], s72 offen offset:0 sc1
  buffer_load_dwordx4 v[132:135], v13, s[20:23], s72 offen offset:1792 sc1
  s_mov_b64 exec, -1
  s_add_u32 s72, s60, s76
  s_add_u32 s72, s72, 28672
  s_mov_b64 exec, s[88:89]
  buffer_load_dwordx4 v[136:139], v16, s[20:23], s72 offen offset:0 sc1
  buffer_load_dwordx4 v[140:143], v16, s[20:23], s72 offen offset:1792 sc1
  s_mov_b64 exec, -1
  s_add_u32 s72, s60, s3
  s_add_u32 s72, s72, 28672
  s_mov_b64 exec, s[88:89]
  buffer_load_dwordx4 v[144:147], v13, s[20:23], s72 offen offset:0 sc1
  buffer_load_dwordx4 v[148:151], v13, s[20:23], s72 offen offset:1792 sc1
  s_mov_b64 exec, -1
  s_add_u32 s72, s60, s3
  s_add_u32 s72, s72, 28672
  s_mov_b64 exec, s[88:89]
  buffer_load_dwordx4 v[152:155], v16, s[20:23], s72 offen offset:0 sc1
  buffer_load_dwordx4 v[156:159], v16, s[20:23], s72 offen offset:1792 sc1
  s_mov_b64 exec, -1
  s_barrier
  v_add_u32 v8, 0x10000, v8
  v_add_u32 v9, 0x10000, v9
  v_add_u32 v10, 0x10000, v10
  v_add_u32 v11, 0x10000, v11
  ds_read_b64_tr_b16 v[32:33], v8 offset:0
  ds_read_b64_tr_b16 v[34:35], v8 offset:1024
  ds_read_b64_tr_b16 v[36:37], v9 offset:0
  ds_read_b64_tr_b16 v[38:39], v9 offset:1024
  ds_read_b64_tr_b16 v[40:41], v10 offset:0
  ds_read_b64_tr_b16 v[42:43], v10 offset:1024
  ds_read_b64_tr_b16 v[44:45], v8 offset:2048
  ds_read_b64_tr_b16 v[46:47], v8 offset:3072
  ds_read_b64_tr_b16 v[48:49], v9 offset:2048
  ds_read_b64_tr_b16 v[50:51], v9 offset:3072
  ds_read_b64_tr_b16 v[52:53], v10 offset:2048
  ds_read_b64_tr_b16 v[54:55], v10 offset:3072
  s_waitcnt lgkmcnt(8)
  s_waitcnt vmcnt(8)
  v_mfma_f32_32x32x16_bf16 v[192:207], v[32:35], v[96:99], v[192:207]
  ds_read_b64_tr_b16 v[56:57], v8 offset:4096
  ds_read_b64_tr_b16 v[58:59], v8 offset:5120
  s_add_u32 s72, s61, s76
  s_add_u32 s72, s72, 28672
  s_mov_b64 exec, s[88:89]
  buffer_load_dwordx4 v[160:163], v13, s[20:23], s72 offen offset:0 sc1
  buffer_load_dwordx4 v[164:167], v13, s[20:23], s72 offen offset:1792 sc1
  s_mov_b64 exec, -1
  v_mfma_f32_32x32x16_bf16 v[208:223], v[36:39], v[96:99], v[208:223]
  ds_read_b64_tr_b16 v[60:61], v9 offset:4096
  ds_read_b64_tr_b16 v[62:63], v9 offset:5120
  s_waitcnt lgkmcnt(8)
  v_mfma_f32_32x32x16_bf16 v[224:239], v[40:43], v[96:99], v[224:239]
  ds_read_b64_tr_b16 v[32:33], v10 offset:4096
  ds_read_b64_tr_b16 v[34:35], v10 offset:5120
  v_mfma_f32_32x32x16_bf16 v[192:207], v[44:47], v[100:103], v[192:207]
  ds_read_b64_tr_b16 v[36:37], v8 offset:6144
  ds_read_b64_tr_b16 v[38:39], v8 offset:7168
  s_add_u32 s72, s61, s76
  s_add_u32 s72, s72, 28672
  s_mov_b64 exec, s[88:89]
  buffer_load_dwordx4 v[168:171], v16, s[20:23], s72 offen offset:0 sc1
  buffer_load_dwordx4 v[172:175], v16, s[20:23], s72 offen offset:1792 sc1
  s_mov_b64 exec, -1
  s_waitcnt lgkmcnt(8)
  v_mfma_f32_32x32x16_bf16 v[208:223], v[48:51], v[100:103], v[208:223]
  ds_read_b64_tr_b16 v[40:41], v9 offset:6144
  ds_read_b64_tr_b16 v[42:43], v9 offset:7168
  v_mfma_f32_32x32x16_bf16 v[224:239], v[52:55], v[100:103], v[224:239]
  ds_read_b64_tr_b16 v[44:45], v10 offset:6144
  ds_read_b64_tr_b16 v[46:47], v10 offset:7168
  s_waitcnt lgkmcnt(8)
  v_mfma_f32_32x32x16_bf16 v[192:207], v[56:59], v[104:107], v[192:207]
  ds_read_b64_tr_b16 v[48:49], v8 offset:16384
  ds_read_b64_tr_b16 v[50:51], v8 offset:17408
  s_add_u32 s72, s61, s3
  s_add_u32 s72, s72, 28672
  s_mov_b64 exec, s[88:89]
  buffer_load_dwordx4 v[176:179], v13, s[20:23], s72 offen offset:0 sc1
  buffer_load_dwordx4 v[180:183], v13, s[20:23], s72 offen offset:1792 sc1
  s_mov_b64 exec, -1
  v_mfma_f32_32x32x16_bf16 v[208:223], v[60:63], v[104:107], v[208:223]
  ds_read_b64_tr_b16 v[52:53], v9 offset:16384
  ds_read_b64_tr_b16 v[54:55], v9 offset:17408
  s_waitcnt lgkmcnt(8)
  v_mfma_f32_32x32x16_bf16 v[224:239], v[32:35], v[104:107], v[224:239]
  ds_read_b64_tr_b16 v[56:57], v10 offset:16384
  ds_read_b64_tr_b16 v[58:59], v10 offset:17408
  v_mfma_f32_32x32x16_bf16 v[192:207], v[36:39], v[108:111], v[192:207]
  ds_read_b64_tr_b16 v[60:61], v8 offset:18432
  ds_read_b64_tr_b16 v[62:63], v8 offset:19456
  s_add_u32 s72, s61, s3
  s_add_u32 s72, s72, 28672
  s_mov_b64 exec, s[88:89]
  buffer_load_dwordx4 v[184:187], v16, s[20:23], s72 offen offset:0 sc1
  buffer_load_dwordx4 v[188:191], v16, s[20:23], s72 offen offset:1792 sc1
  s_mov_b64 exec, -1
  s_waitcnt lgkmcnt(8)
  v_mfma_f32_32x32x16_bf16 v[208:223], v[40:43], v[108:111], v[208:223]
  ds_read_b64_tr_b16 v[32:33], v9 offset:18432
  ds_read_b64_tr_b16 v[34:35], v9 offset:19456
  v_mfma_f32_32x32x16_bf16 v[224:239], v[44:47], v[108:111], v[224:239]
  ds_read_b64_tr_b16 v[36:37], v10 offset:18432
  ds_read_b64_tr_b16 v[38:39], v10 offset:19456
  s_waitcnt lgkmcnt(8)
  v_mfma_f32_32x32x16_bf16 v[192:207], v[48:51], v[112:115], v[192:207]
  ds_read_b64_tr_b16 v[40:41], v8 offset:20480
  ds_read_b64_tr_b16 v[42:43], v8 offset:21504
  v_mfma_f32_32x32x16_bf16 v[208:223], v[52:55], v[112:115], v[208:223]
  ds_read_b64_tr_b16 v[44:45], v9 offset:20480
  ds_read_b64_tr_b16 v[46:47], v9 offset:21504
  s_waitcnt lgkmcnt(8)
  v_mfma_f32_32x32x16_bf16 v[224:239], v[56:59], v[112:115], v[224:239]
  ds_read_b64_tr_b16 v[48:49], v10 offset:20480
  ds_read_b64_tr_b16 v[50:51], v10 offset:21504
  v_mfma_f32_32x32x16_bf16 v[192:207], v[60:63], v[116:119], v[192:207]
  ds_read_b64_tr_b16 v[52:53], v8 offset:22528
  ds_read_b64_tr_b16 v[54:55], v8 offset:23552
  s_waitcnt lgkmcnt(8)
  v_mfma_f32_32x32x16_bf16 v[208:223], v[32:35], v[116:119], v[208:223]
  ds_read_b64_tr_b16 v[56:57], v9 offset:22528
  ds_read_b64_tr_b16 v[58:59], v9 offset:23552
  v_mfma_f32_32x32x16_bf16 v[224:239], v[36:39], v[116:119], v[224:239]
  ds_read_b64_tr_b16 v[60:61], v10 offset:22528
  ds_read_b64_tr_b16 v[62:63], v10 offset:23552
  s_waitcnt lgkmcnt(8)
  v_mfma_f32_32x32x16_bf16 v[192:207], v[40:43], v[120:123], v[192:207]
  ds_read_b64_tr_b16 v[32:33], v8 offset:32768
  ds_read_b64_tr_b16 v[34:35], v8 offset:33792
  v_mfma_f32_32x32x16_bf16 v[208:223], v[44:47], v[120:123], v[208:223]
  ds_read_b64_tr_b16 v[36:37], v9 offset:32768
  ds_read_b64_tr_b16 v[38:39], v9 offset:33792
  s_waitcnt lgkmcnt(8)
  v_mfma_f32_32x32x16_bf16 v[224:239], v[48:51], v[120:123], v[224:239]
  ds_read_b64_tr_b16 v[40:41], v10 offset:32768
  ds_read_b64_tr_b16 v[42:43], v10 offset:33792
  v_mfma_f32_32x32x16_bf16 v[192:207], v[52:55], v[124:127], v[192:207]
  ds_read_b64_tr_b16 v[44:45], v8 offset:34816
  ds_read_b64_tr_b16 v[46:47], v8 offset:35840
  s_waitcnt lgkmcnt(8)
  v_mfma_f32_32x32x16_bf16 v[208:223], v[56:59], v[124:127], v[208:223]
  ds_read_b64_tr_b16 v[48:49], v9 offset:34816
  ds_read_b64_tr_b16 v[50:51], v9 offset:35840
  v_mfma_f32_32x32x16_bf16 v[224:239], v[60:63], v[124:127], v[224:239]
  ds_read_b64_tr_b16 v[52:53], v10 offset:34816
  ds_read_b64_tr_b16 v[54:55], v10 offset:35840
  s_waitcnt vmcnt(8)
  s_waitcnt lgkmcnt(8)
  v_mfma_f32_32x32x16_bf16 v[192:207], v[32:35], v[128:131], v[192:207]
  ds_read_b64_tr_b16 v[56:57], v8 offset:36864
  ds_read_b64_tr_b16 v[58:59], v8 offset:37888
  v_mfma_f32_32x32x16_bf16 v[208:223], v[36:39], v[128:131], v[208:223]
  ds_read_b64_tr_b16 v[60:61], v9 offset:36864
  ds_read_b64_tr_b16 v[62:63], v9 offset:37888
  s_waitcnt lgkmcnt(8)
  v_mfma_f32_32x32x16_bf16 v[224:239], v[40:43], v[128:131], v[224:239]
  ds_read_b64_tr_b16 v[32:33], v10 offset:36864
  ds_read_b64_tr_b16 v[34:35], v10 offset:37888
  v_mfma_f32_32x32x16_bf16 v[192:207], v[44:47], v[132:135], v[192:207]
  ds_read_b64_tr_b16 v[36:37], v8 offset:38912
  ds_read_b64_tr_b16 v[38:39], v8 offset:39936
  s_waitcnt lgkmcnt(8)
  v_mfma_f32_32x32x16_bf16 v[208:223], v[48:51], v[132:135], v[208:223]
  ds_read_b64_tr_b16 v[40:41], v9 offset:38912
  ds_read_b64_tr_b16 v[42:43], v9 offset:39936
  v_mfma_f32_32x32x16_bf16 v[224:239], v[52:55], v[132:135], v[224:239]
  ds_read_b64_tr_b16 v[44:45], v10 offset:38912
  ds_read_b64_tr_b16 v[46:47], v10 offset:39936
  s_waitcnt lgkmcnt(8)
  v_mfma_f32_32x32x16_bf16 v[192:207], v[56:59], v[136:139], v[192:207]
  ds_read_b64_tr_b16 v[48:49], v8 offset:49152
  ds_read_b64_tr_b16 v[50:51], v8 offset:50176
  v_mfma_f32_32x32x16_bf16 v[208:223], v[60:63], v[136:139], v[208:223]
  ds_read_b64_tr_b16 v[52:53], v9 offset:49152
  ds_read_b64_tr_b16 v[54:55], v9 offset:50176
  s_waitcnt lgkmcnt(8)
  v_mfma_f32_32x32x16_bf16 v[224:239], v[32:35], v[136:139], v[224:239]
  ds_read_b64_tr_b16 v[56:57], v10 offset:49152
  ds_read_b64_tr_b16 v[58:59], v10 offset:50176
  v_mfma_f32_32x32x16_bf16 v[192:207], v[36:39], v[140:143], v[192:207]
  ds_read_b64_tr_b16 v[60:61], v8 offset:51200
  ds_read_b64_tr_b16 v[62:63], v8 offset:52224
  s_waitcnt lgkmcnt(8)
  v_mfma_f32_32x32x16_bf16 v[208:223], v[40:43], v[140:143], v[208:223]
  ds_read_b64_tr_b16 v[32:33], v9 offset:51200
  ds_read_b64_tr_b16 v[34:35], v9 offset:52224
  v_mfma_f32_32x32x16_bf16 v[224:239], v[44:47], v[140:143], v[224:239]
  ds_read_b64_tr_b16 v[36:37], v10 offset:51200
  ds_read_b64_tr_b16 v[38:39], v10 offset:52224
  s_waitcnt lgkmcnt(8)
  v_mfma_f32_32x32x16_bf16 v[192:207], v[48:51], v[144:147], v[192:207]
  ds_read_b64_tr_b16 v[40:41], v8 offset:53248
  ds_read_b64_tr_b16 v[42:43], v8 offset:54272
  v_mfma_f32_32x32x16_bf16 v[208:223], v[52:55], v[144:147], v[208:223]
  ds_read_b64_tr_b16 v[44:45], v9 offset:53248
  ds_read_b64_tr_b16 v[46:47], v9 offset:54272
  s_waitcnt lgkmcnt(8)
  v_mfma_f32_32x32x16_bf16 v[224:239], v[56:59], v[144:147], v[224:239]
  ds_read_b64_tr_b16 v[48:49], v10 offset:53248
  ds_read_b64_tr_b16 v[50:51], v10 offset:54272
  v_mfma_f32_32x32x16_bf16 v[192:207], v[60:63], v[148:151], v[192:207]
  ds_read_b64_tr_b16 v[52:53], v8 offset:55296
  ds_read_b64_tr_b16 v[54:55], v8 offset:56320
  s_waitcnt lgkmcnt(8)
  v_mfma_f32_32x32x16_bf16 v[208:223], v[32:35], v[148:151], v[208:223]
  ds_read_b64_tr_b16 v[56:57], v9 offset:55296
  ds_read_b64_tr_b16 v[58:59], v9 offset:56320
  v_mfma_f32_32x32x16_bf16 v[224:239], v[36:39], v[148:151], v[224:239]
  ds_read_b64_tr_b16 v[60:61], v10 offset:55296
  ds_read_b64_tr_b16 v[62:63], v10 offset:56320
  s_waitcnt lgkmcnt(8)
  v_mfma_f32_32x32x16_bf16 v[192:207], v[40:43], v[152:155], v[192:207]
  v_add_u32 v8, 0xffff0000, v8
  v_add_u32 v9, 0xffff0000, v9
  v_add_u32 v10, 0xffff0000, v10
  v_add_u32 v11, 0xffff0000, v11
  ds_read_b64_tr_b16 v[32:33], v8 offset:0
  ds_read_b64_tr_b16 v[34:35], v8 offset:1024
  v_mfma_f32_32x32x16_bf16 v[208:223], v[44:47], v[152:155], v[208:223]
  ds_read_b64_tr_b16 v[36:37], v8 offset:2048
  ds_read_b64_tr_b16 v[38:39], v8 offset:3072
  s_waitcnt lgkmcnt(8)
  v_mfma_f32_32x32x16_bf16 v[224:239], v[48:51], v[152:155], v[224:239]
  ds_read_b64_tr_b16 v[40:41], v8 offset:4096
  ds_read_b64_tr_b16 v[42:43], v8 offset:5120
  v_mfma_f32_32x32x16_bf16 v[192:207], v[52:55], v[156:159], v[192:207]
  ds_read_b64_tr_b16 v[44:45], v8 offset:6144
  ds_read_b64_tr_b16 v[46:47], v8 offset:7168
  s_waitcnt lgkmcnt(8)
  v_mfma_f32_32x32x16_bf16 v[208:223], v[56:59], v[156:159], v[208:223]
  ds_read_b64_tr_b16 v[48:49], v8 offset:32768
  ds_read_b64_tr_b16 v[50:51], v8 offset:33792
  v_mfma_f32_32x32x16_bf16 v[224:239], v[60:63], v[156:159], v[224:239]
  ds_read_b64_tr_b16 v[52:53], v8 offset:34816
  ds_read_b64_tr_b16 v[54:55], v8 offset:35840
  s_waitcnt vmcnt(0)
  s_waitcnt lgkmcnt(8)
  v_mfma_f32_32x32x16_bf16 v[192:207], v[32:35], v[160:163], v[192:207]
  ds_read_b64_tr_b16 v[56:57], v8 offset:36864
  ds_read_b64_tr_b16 v[58:59], v8 offset:37888
  s_mul_i32 s71, s65, 43008
  s_add_u32 s73, s73, s71
  v_mfma_f32_32x32x16_bf16 v[192:207], v[36:39], v[164:167], v[192:207]
  ds_read_b64_tr_b16 v[60:61], v8 offset:38912
  ds_read_b64_tr_b16 v[62:63], v8 offset:39936
  s_waitcnt lgkmcnt(8)
  v_mfma_f32_32x32x16_bf16 v[192:207], v[40:43], v[168:171], v[192:207]
  ds_read_b64_tr_b16 v[32:33], v9 offset:0
  ds_read_b64_tr_b16 v[34:35], v9 offset:1024
  v_mfma_f32_32x32x16_bf16 v[192:207], v[44:47], v[172:175], v[192:207]
  ds_read_b64_tr_b16 v[36:37], v9 offset:2048
  ds_read_b64_tr_b16 v[38:39], v9 offset:3072
  s_waitcnt lgkmcnt(8)
  v_mfma_f32_32x32x16_bf16 v[192:207], v[48:51], v[176:179], v[192:207]
  ds_read_b64_tr_b16 v[40:41], v9 offset:4096
  ds_read_b64_tr_b16 v[42:43], v9 offset:5120
  v_mfma_f32_32x32x16_bf16 v[192:207], v[52:55], v[180:183], v[192:207]
  ds_read_b64_tr_b16 v[44:45], v9 offset:6144
  ds_read_b64_tr_b16 v[46:47], v9 offset:7168
  s_waitcnt lgkmcnt(8)
  v_mfma_f32_32x32x16_bf16 v[192:207], v[56:59], v[184:187], v[192:207]
  ds_read_b64_tr_b16 v[48:49], v9 offset:32768
  ds_read_b64_tr_b16 v[50:51], v9 offset:33792
  v_mfma_f32_32x32x16_bf16 v[192:207], v[60:63], v[188:191], v[192:207]
  ds_read_b64_tr_b16 v[52:53], v9 offset:34816
  ds_read_b64_tr_b16 v[54:55], v9 offset:35840
  s_waitcnt lgkmcnt(8)
  v_mfma_f32_32x32x16_bf16 v[208:223], v[32:35], v[160:163], v[208:223]
  ds_read_b64_tr_b16 v[56:57], v9 offset:36864
  ds_read_b64_tr_b16 v[58:59], v9 offset:37888
  v_mfma_f32_32x32x16_bf16 v[208:223], v[36:39], v[164:167], v[208:223]
  ds_read_b64_tr_b16 v[60:61], v9 offset:38912
  ds_read_b64_tr_b16 v[62:63], v9 offset:39936
  s_waitcnt lgkmcnt(8)
  v_mfma_f32_32x32x16_bf16 v[208:223], v[40:43], v[168:171], v[208:223]
  ds_read_b64_tr_b16 v[32:33], v10 offset:0
  ds_read_b64_tr_b16 v[34:35], v10 offset:1024
  v_mfma_f32_32x32x16_bf16 v[208:223], v[44:47], v[172:175], v[208:223]
  ds_read_b64_tr_b16 v[36:37], v10 offset:2048
  ds_read_b64_tr_b16 v[38:39], v10 offset:3072
  v_bfi_b32 v192, v24, s82, v192
  v_bfi_b32 v193, v24, s84, v193
  v_bfi_b32 v194, v24, s78, v194
  v_bfi_b32 v195, v24, s80, v195
  s_add_u32 s70, s54, 0
  s_mov_b64 exec, s[88:89]
  buffer_store_dwordx4 v[192:195], v23, s[20:23], s70 offen sc1
  s_mov_b64 exec, -1
  s_waitcnt lgkmcnt(8)
  v_mfma_f32_32x32x16_bf16 v[208:223], v[48:51], v[176:179], v[208:223]
  ds_read_b64_tr_b16 v[40:41], v10 offset:4096
  ds_read_b64_tr_b16 v[42:43], v10 offset:5120
  v_bfi_b32 v196, v24, s82, v196
  v_bfi_b32 v197, v24, s84, v197
  v_bfi_b32 v198, v24, s78, v198
  v_bfi_b32 v199, v24, s80, v199
  s_add_u32 s70, s54, 3584
  s_mov_b64 exec, s[88:89]
  buffer_store_dwordx4 v[196:199], v23, s[20:23], s70 offen sc1
  s_mov_b64 exec, -1
  v_mfma_f32_32x32x16_bf16 v[208:223], v[52:55], v[180:183], v[208:223]
  ds_read_b64_tr_b16 v[44:45], v10 offset:6144
  ds_read_b64_tr_b16 v[46:47], v10 offset:7168
  v_bfi_b32 v200, v24, s82, v200
  v_bfi_b32 v201, v24, s84, v201
  v_bfi_b32 v202, v24, s78, v202
  v_bfi_b32 v203, v24, s80, v203
  s_add_u32 s70, s54, 7168
  s_mov_b64 exec, s[88:89]
  buffer_store_dwordx4 v[200:203], v23, s[20:23], s70 offen sc1
  s_mov_b64 exec, -1
  s_waitcnt lgkmcnt(8)
  v_mfma_f32_32x32x16_bf16 v[208:223], v[56:59], v[184:187], v[208:223]
  ds_read_b64_tr_b16 v[48:49], v10 offset:32768
  ds_read_b64_tr_b16 v[50:51], v10 offset:33792
  v_bfi_b32 v204, v24, s82, v204
  v_bfi_b32 v205, v24, s84, v205
  v_bfi_b32 v206, v24, s78, v206
  v_bfi_b32 v207, v24, s80, v207
  s_add_u32 s70, s54, 10752
  s_mov_b64 exec, s[88:89]
  buffer_store_dwordx4 v[204:207], v23, s[20:23], s70 offen sc1
  s_mov_b64 exec, -1
  v_mfma_f32_32x32x16_bf16 v[208:223], v[60:63], v[188:191], v[208:223]
  ds_read_b64_tr_b16 v[52:53], v10 offset:34816
  ds_read_b64_tr_b16 v[54:55], v10 offset:35840
  s_waitcnt lgkmcnt(8)
  v_mfma_f32_32x32x16_bf16 v[224:239], v[32:35], v[160:163], v[224:239]
  ds_read_b64_tr_b16 v[56:57], v10 offset:36864
  ds_read_b64_tr_b16 v[58:59], v10 offset:37888
  v_mfma_f32_32x32x16_bf16 v[224:239], v[36:39], v[164:167], v[224:239]
  ds_read_b64_tr_b16 v[60:61], v10 offset:38912
  ds_read_b64_tr_b16 v[62:63], v10 offset:39936
  s_waitcnt lgkmcnt(8)
  v_mfma_f32_32x32x16_bf16 v[224:239], v[40:43], v[168:171], v[224:239]
  v_add_u32 v8, 0x10000, v8
  v_add_u32 v9, 0x10000, v9
  v_add_u32 v10, 0x10000, v10
  v_add_u32 v11, 0x10000, v11
  ds_read_b64_tr_b16 v[32:33], v11 offset:0
  ds_read_b64_tr_b16 v[34:35], v11 offset:1024
  v_mfma_f32_32x32x16_bf16 v[224:239], v[44:47], v[172:175], v[224:239]
  ds_read_b64_tr_b16 v[36:37], v11 offset:2048
  ds_read_b64_tr_b16 v[38:39], v11 offset:3072
  v_bfi_b32 v208, v24, s82, v208
  v_bfi_b32 v209, v24, s84, v209
  v_bfi_b32 v210, v24, s78, v210
  v_bfi_b32 v211, v24, s80, v211
  s_add_u32 s70, s55, 0
  s_mov_b64 exec, s[88:89]
  buffer_store_dwordx4 v[208:211], v23, s[20:23], s70 offen sc1
  s_mov_b64 exec, -1
  s_waitcnt lgkmcnt(8)
  v_mfma_f32_32x32x16_bf16 v[224:239], v[48:51], v[176:179], v[224:239]
  ds_read_b64_tr_b16 v[40:41], v11 offset:4096
  ds_read_b64_tr_b16 v[42:43], v11 offset:5120
  v_bfi_b32 v212, v24, s82, v212
  v_bfi_b32 v213, v24, s84, v213
  v_bfi_b32 v214, v24, s78, v214
  v_bfi_b32 v215, v24, s80, v215
  s_add_u32 s70, s55, 3584
  s_mov_b64 exec, s[88:89]
  buffer_store_dwordx4 v[212:215], v23, s[20:23], s70 offen sc1
  s_mov_b64 exec, -1
  v_mfma_f32_32x32x16_bf16 v[224:239], v[52:55], v[180:183], v[224:239]
  ds_read_b64_tr_b16 v[44:45], v11 offset:6144
  ds_read_b64_tr_b16 v[46:47], v11 offset:7168
  v_bfi_b32 v216, v24, s82, v216
  v_bfi_b32 v217, v24, s84, v217
  v_bfi_b32 v218, v24, s78, v218
  v_bfi_b32 v219, v24, s80, v219
  s_add_u32 s70, s55, 7168
  s_mov_b64 exec, s[88:89]
  buffer_store_dwordx4 v[216:219], v23, s[20:23], s70 offen sc1
  s_mov_b64 exec, -1
  s_waitcnt lgkmcnt(8)
  v_mfma_f32_32x32x16_bf16 v[224:239], v[56:59], v[184:187], v[224:239]
  ds_read_b64_tr_b16 v[48:49], v11 offset:16384
  ds_read_b64_tr_b16 v[50:51], v11 offset:17408
  v_bfi_b32 v220, v24, s82, v220
  v_bfi_b32 v221, v24, s84, v221
  v_bfi_b32 v222, v24, s78, v222
  v_bfi_b32 v223, v24, s80, v223
  s_add_u32 s70, s55, 10752
  s_mov_b64 exec, s[88:89]
  buffer_store_dwordx4 v[220:223], v23, s[20:23], s70 offen sc1
  s_mov_b64 exec, -1
  v_mfma_f32_32x32x16_bf16 v[224:239], v[60:63], v[188:191], v[224:239]
  ds_read_b64_tr_b16 v[52:53], v11 offset:18432
  ds_read_b64_tr_b16 v[54:55], v11 offset:19456
  s_waitcnt lgkmcnt(8)
  v_mfma_f32_32x32x16_bf16 v[240:255], v[32:35], v[96:99], v[240:255]
  ds_read_b64_tr_b16 v[56:57], v11 offset:20480
  ds_read_b64_tr_b16 v[58:59], v11 offset:21504
  v_mfma_f32_32x32x16_bf16 v[240:255], v[36:39], v[100:103], v[240:255]
  ds_read_b64_tr_b16 v[60:61], v11 offset:22528
  ds_read_b64_tr_b16 v[62:63], v11 offset:23552
  s_waitcnt lgkmcnt(8)
  v_mfma_f32_32x32x16_bf16 v[240:255], v[40:43], v[104:107], v[240:255]
  ds_read_b64_tr_b16 v[32:33], v11 offset:32768
  ds_read_b64_tr_b16 v[34:35], v11 offset:33792
  v_mfma_f32_32x32x16_bf16 v[240:255], v[44:47], v[108:111], v[240:255]
  ds_read_b64_tr_b16 v[36:37], v11 offset:34816
  ds_read_b64_tr_b16 v[38:39], v11 offset:35840
  v_bfi_b32 v224, v24, s82, v224
  v_bfi_b32 v225, v24, s84, v225
  v_bfi_b32 v226, v24, s78, v226
  v_bfi_b32 v227, v24, s80, v227
  s_add_u32 s70, s56, 0
  s_mov_b64 exec, s[88:89]
  buffer_store_dwordx4 v[224:227], v23, s[20:23], s70 offen sc1
  s_mov_b64 exec, -1
  s_waitcnt lgkmcnt(8)
  v_mfma_f32_32x32x16_bf16 v[240:255], v[48:51], v[112:115], v[240:255]
  ds_read_b64_tr_b16 v[40:41], v11 offset:36864
  ds_read_b64_tr_b16 v[42:43], v11 offset:37888
  v_bfi_b32 v228, v24, s82, v228
  v_bfi_b32 v229, v24, s84, v229
  v_bfi_b32 v230, v24, s78, v230
  v_bfi_b32 v231, v24, s80, v231
  s_add_u32 s70, s56, 3584
  s_mov_b64 exec, s[88:89]
  buffer_store_dwordx4 v[228:231], v23, s[20:23], s70 offen sc1
  s_mov_b64 exec, -1
  v_mfma_f32_32x32x16_bf16 v[240:255], v[52:55], v[116:119], v[240:255]
  ds_read_b64_tr_b16 v[44:45], v11 offset:38912
  ds_read_b64_tr_b16 v[46:47], v11 offset:39936
  v_bfi_b32 v232, v24, s82, v232
  v_bfi_b32 v233, v24, s84, v233
  v_bfi_b32 v234, v24, s78, v234
  v_bfi_b32 v235, v24, s80, v235
  s_add_u32 s70, s56, 7168
  s_mov_b64 exec, s[88:89]
  buffer_store_dwordx4 v[232:235], v23, s[20:23], s70 offen sc1
  s_mov_b64 exec, -1
  s_waitcnt lgkmcnt(8)
  v_mfma_f32_32x32x16_bf16 v[240:255], v[56:59], v[120:123], v[240:255]
  ds_read_b64_tr_b16 v[48:49], v11 offset:49152
  ds_read_b64_tr_b16 v[50:51], v11 offset:50176
  v_bfi_b32 v236, v24, s82, v236
  v_bfi_b32 v237, v24, s84, v237
  v_bfi_b32 v238, v24, s78, v238
  v_bfi_b32 v239, v24, s80, v239
  s_add_u32 s70, s56, 10752
  s_mov_b64 exec, s[88:89]
  buffer_store_dwordx4 v[236:239], v23, s[20:23], s70 offen sc1
  s_mov_b64 exec, -1
  v_mfma_f32_32x32x16_bf16 v[240:255], v[60:63], v[124:127], v[240:255]
  ds_read_b64_tr_b16 v[52:53], v11 offset:51200
  ds_read_b64_tr_b16 v[54:55], v11 offset:52224
  s_waitcnt lgkmcnt(8)
  v_mfma_f32_32x32x16_bf16 v[240:255], v[32:35], v[128:131], v[240:255]
  ds_read_b64_tr_b16 v[56:57], v11 offset:53248
  ds_read_b64_tr_b16 v[58:59], v11 offset:54272
  v_mfma_f32_32x32x16_bf16 v[240:255], v[36:39], v[132:135], v[240:255]
  ds_read_b64_tr_b16 v[60:61], v11 offset:55296
  ds_read_b64_tr_b16 v[62:63], v11 offset:56320
  s_waitcnt lgkmcnt(8)
  v_mfma_f32_32x32x16_bf16 v[240:255], v[40:43], v[136:139], v[240:255]
  v_add_u32 v8, 0xffff0000, v8
  v_add_u32 v9, 0xffff0000, v9
  v_add_u32 v10, 0xffff0000, v10
  v_add_u32 v11, 0xffff0000, v11
  ds_read_b64_tr_b16 v[32:33], v11 offset:0
  ds_read_b64_tr_b16 v[34:35], v11 offset:1024
  v_mfma_f32_32x32x16_bf16 v[240:255], v[44:47], v[140:143], v[240:255]
  ds_read_b64_tr_b16 v[36:37], v11 offset:2048
  ds_read_b64_tr_b16 v[38:39], v11 offset:3072
  s_waitcnt lgkmcnt(8)
  v_mfma_f32_32x32x16_bf16 v[240:255], v[48:51], v[144:147], v[240:255]
  ds_read_b64_tr_b16 v[40:41], v11 offset:4096
  ds_read_b64_tr_b16 v[42:43], v11 offset:5120
  v_mfma_f32_32x32x16_bf16 v[240:255], v[52:55], v[148:151], v[240:255]
  ds_read_b64_tr_b16 v[44:45], v11 offset:6144
  ds_read_b64_tr_b16 v[46:47], v11 offset:7168
  s_waitcnt lgkmcnt(8)
  v_mfma_f32_32x32x16_bf16 v[240:255], v[56:59], v[152:155], v[240:255]
  ds_read_b64_tr_b16 v[48:49], v11 offset:32768
  ds_read_b64_tr_b16 v[50:51], v11 offset:33792
  v_mfma_f32_32x32x16_bf16 v[240:255], v[60:63], v[156:159], v[240:255]
  ds_read_b64_tr_b16 v[52:53], v11 offset:34816
  ds_read_b64_tr_b16 v[54:55], v11 offset:35840
  s_waitcnt lgkmcnt(8)
  v_mfma_f32_32x32x16_bf16 v[240:255], v[32:35], v[160:163], v[240:255]
  ds_read_b64_tr_b16 v[56:57], v11 offset:36864
  ds_read_b64_tr_b16 v[58:59], v11 offset:37888
  v_mfma_f32_32x32x16_bf16 v[240:255], v[36:39], v[164:167], v[240:255]
  ds_read_b64_tr_b16 v[60:61], v11 offset:38912
  ds_read_b64_tr_b16 v[62:63], v11 offset:39936
  s_waitcnt lgkmcnt(8)
  v_mfma_f32_32x32x16_bf16 v[240:255], v[40:43], v[168:171], v[240:255]
  v_mfma_f32_32x32x16_bf16 v[240:255], v[44:47], v[172:175], v[240:255]
  s_waitcnt lgkmcnt(4)
  v_mfma_f32_32x32x16_bf16 v[240:255], v[48:51], v[176:179], v[240:255]
  v_mfma_f32_32x32x16_bf16 v[240:255], v[52:55], v[180:183], v[240:255]
  s_waitcnt lgkmcnt(0)
  v_mfma_f32_32x32x16_bf16 v[240:255], v[56:59], v[184:187], v[240:255]
  v_mfma_f32_32x32x16_bf16 v[240:255], v[60:63], v[188:191], v[240:255]
  s_mov_b64 exec, s[88:89]
  s_mov_b32 s87, 0
  s_add_u32 s70, s73, 28672
  buffer_load_dwordx4 v[64:67], v23, s[20:23], s70 offen sc1
  s_add_u32 s70, s73, 32256
  buffer_load_dwordx4 v[68:71], v23, s[20:23], s70 offen sc1
  s_add_u32 s70, s73, 35840
  buffer_load_dwordx4 v[72:75], v23, s[20:23], s70 offen sc1
  s_add_u32 s70, s73, 39424
  buffer_load_dwordx4 v[76:79], v23, s[20:23], s70 offen sc1
  s_add_u32 s70, s73, 14336
  buffer_load_dwordx4 v[80:83], v23, s[20:23], s70 offen sc1
  s_add_u32 s70, s73, 17920
  buffer_load_dwordx4 v[84:87], v23, s[20:23], s70 offen sc1
  s_add_u32 s70, s73, 21504
  buffer_load_dwordx4 v[88:91], v23, s[20:23], s70 offen sc1
  s_add_u32 s70, s73, 25088
  buffer_load_dwordx4 v[92:95], v23, s[20:23], s70 offen sc1
  s_mul_i32 s72, s66, 229376
  s_lshl_b32 s71, s64, 10
  s_add_u32 s72, s72, s71
  s_lshl_b32 s71, s67, 8
  s_add_u32 s72, s72, s71
  s_lshl_b32 s71, s65, 6
  s_add_u32 s72, s72, s71
  s_waitcnt vmcnt(4)
  v_xor_b32 v25, s82, v64
  v_xor_b32 v26, s84, v65
  v_bitop3_b32 v25, v25, v66, s78 bitop3:0xf6
  v_bitop3_b32 v26, v26, v67, s80 bitop3:0xf6
  v_bitop3_b32 v25, v25, v68, s82 bitop3:0xf6
  v_bitop3_b32 v26, v26, v69, s84 bitop3:0xf6
  v_bitop3_b32 v25, v25, v70, s78 bitop3:0xf6
  v_bitop3_b32 v26, v26, v71, s80 bitop3:0xf6
  v_bitop3_b32 v25, v25, v72, s82 bitop3:0xf6
  v_bitop3_b32 v26, v26, v73, s84 bitop3:0xf6
  v_bitop3_b32 v25, v25, v74, s78 bitop3:0xf6
  v_bitop3_b32 v26, v26, v75, s80 bitop3:0xf6
  v_bitop3_b32 v25, v25, v76, s82 bitop3:0xf6
  v_bitop3_b32 v26, v26, v77, s84 bitop3:0xf6
  v_bitop3_b32 v25, v25, v78, s78 bitop3:0xf6
  v_bitop3_b32 v26, v26, v79, s80 bitop3:0xf6
  v_or_b32 v25, v25, v26
  v_and_b32 v25, v24, v25
  v_cmp_ne_u32 vcc, 0, v25
  s_nop 0
  s_cbranch_vccnz B_r2
B_r2r:
  v_pk_add_f32 v[240:241], v[240:241], v[64:65]
  v_pk_add_f32 v[242:243], v[242:243], v[66:67]
  v_pk_add_f32 v[244:245], v[244:245], v[68:69]
  v_pk_add_f32 v[246:247], v[246:247], v[70:71]
  v_pk_add_f32 v[248:249], v[248:249], v[72:73]
  v_pk_add_f32 v[250:251], v[250:251], v[74:75]
  v_pk_add_f32 v[252:253], v[252:253], v[76:77]
  v_pk_add_f32 v[254:255], v[254:255], v[78:79]
  s_waitcnt vmcnt(0)
  s_add_u32 s70, s73, 0
  buffer_load_dwordx4 v[96:99], v23, s[20:23], s70 offen sc1
  s_add_u32 s70, s73, 3584
  buffer_load_dwordx4 v[100:103], v23, s[20:23], s70 offen sc1
  s_add_u32 s70, s73, 7168
  buffer_load_dwordx4 v[104:107], v23, s[20:23], s70 offen sc1
  s_add_u32 s70, s73, 10752
  buffer_load_dwordx4 v[108:111], v23, s[20:23], s70 offen sc1
  v_xor_b32 v25, s82, v80
  v_xor_b32 v26, s84, v81
  v_bitop3_b32 v25, v25, v82, s78 bitop3:0xf6
  v_bitop3_b32 v26, v26, v83, s80 bitop3:0xf6
  v_bitop3_b32 v25, v25, v84, s82 bitop3:0xf6
  v_bitop3_b32 v26, v26, v85, s84 bitop3:0xf6
  v_bitop3_b32 v25, v25, v86, s78 bitop3:0xf6
  v_bitop3_b32 v26, v26, v87, s80 bitop3:0xf6
  v_bitop3_b32 v25, v25, v88, s82 bitop3:0xf6
  v_bitop3_b32 v26, v26, v89, s84 bitop3:0xf6
  v_bitop3_b32 v25, v25, v90, s78 bitop3:0xf6
  v_bitop3_b32 v26, v26, v91, s80 bitop3:0xf6
  v_bitop3_b32 v25, v25, v92, s82 bitop3:0xf6
  v_bitop3_b32 v26, v26, v93, s84 bitop3:0xf6
  v_bitop3_b32 v25, v25, v94, s78 bitop3:0xf6
  v_bitop3_b32 v26, v26, v95, s80 bitop3:0xf6
  v_or_b32 v25, v25, v26
  v_and_b32 v25, v24, v25
  v_cmp_ne_u32 vcc, 0, v25
  s_nop 0
  s_cbranch_vccnz B_r1
B_r1r:
  v_pk_add_f32 v[240:241], v[240:241], v[80:81]
  v_pk_add_f32 v[242:243], v[242:243], v[82:83]
  v_pk_add_f32 v[244:245], v[244:245], v[84:85]
  v_pk_add_f32 v[246:247], v[246:247], v[86:87]
  v_pk_add_f32 v[248:249], v[248:249], v[88:89]
  v_pk_add_f32 v[250:251], v[250:251], v[90:91]
  v_pk_add_f32 v[252:253], v[252:253], v[92:93]
  v_pk_add_f32 v[254:255], v[254:255], v[94:95]
  s_waitcnt vmcnt(0)
  v_xor_b32 v25, s82, v96
  v_xor_b32 v26, s84, v97
  v_bitop3_b32 v25, v25, v98, s78 bitop3:0xf6
  v_bitop3_b32 v26, v26, v99, s80 bitop3:0xf6
  v_bitop3_b32 v25, v25, v100, s82 bitop3:0xf6
  v_bitop3_b32 v26, v26, v101, s84 bitop3:0xf6
  v_bitop3_b32 v25, v25, v102, s78 bitop3:0xf6
  v_bitop3_b32 v26, v26, v103, s80 bitop3:0xf6
  v_bitop3_b32 v25, v25, v104, s82 bitop3:0xf6
  v_bitop3_b32 v26, v26, v105, s84 bitop3:0xf6
  v_bitop3_b32 v25, v25, v106, s78 bitop3:0xf6
  v_bitop3_b32 v26, v26, v107, s80 bitop3:0xf6
  v_bitop3_b32 v25, v25, v108, s82 bitop3:0xf6
  v_bitop3_b32 v26, v26, v109, s84 bitop3:0xf6
  v_bitop3_b32 v25, v25, v110, s78 bitop3:0xf6
  v_bitop3_b32 v26, v26, v111, s80 bitop3:0xf6
  v_or_b32 v25, v25, v26
  v_and_b32 v25, v24, v25
  v_cmp_ne_u32 vcc, 0, v25
  s_nop 0
  s_cbranch_vccnz B_r0
B_r0r:
  v_pk_add_f32 v[240:241], v[240:241], v[96:97]
  v_pk_add_f32 v[242:243], v[242:243], v[98:99]
  v_pk_add_f32 v[244:245], v[244:245], v[100:101]
  v_pk_add_f32 v[246:247], v[246:247], v[102:103]
  v_pk_add_f32 v[248:249], v[248:249], v[104:105]
  v_pk_add_f32 v[250:251], v[250:251], v[106:107]
  v_pk_add_f32 v[252:253], v[252:253], v[108:109]
  v_pk_add_f32 v[254:255], v[254:255], v[110:111]
  s_mov_b32 s70, s72
  v_cvt_pk_bf16_f32 v32, v240, v241
  v_cvt_pk_bf16_f32 v33, v242, v243
  v_cvt_pk_bf16_f32 v34, v244, v245
  v_cvt_pk_bf16_f32 v35, v246, v247
  v_cvt_pk_bf16_f32 v36, v248, v249
  v_cvt_pk_bf16_f32 v37, v250, v251
  v_cvt_pk_bf16_f32 v38, v252, v253
  v_cvt_pk_bf16_f32 v39, v254, v255
  buffer_store_dwordx4 v[32:35], v19, s[28:31], s70 offen offset:0
  buffer_store_dwordx4 v[36:39], v19, s[28:31], s70 offen offset:32
  s_cmp_lg_u32 s65, 0
  s_cbranch_scc1 B_ncell
  s_lshr_b32 s72, s85, 4
  s_lshl_b32 s72, s72, 2
  s_add_u32 s72, s72, s67
  s_lshl_b32 s72, s72, 7
  s_lshl_b32 s71, s63, 2
  s_add_u32 s72, s72, s71
  s_add_u32 s72, s72, 33619968
  v_mov_b32 v20, s69
  s_mov_b64 exec, 1
  buffer_store_dword v20, off, s[20:23], s72 sc1
B_ncell:
  s_mov_b64 exec, -1
  s_endpgm
B_r2:
  s_add_u32 s87, s87, 1
  s_cmp_ge_u32 s87, 4096
  s_cbranch_scc1 B_r2r
  s_add_u32 s70, s73, 28672
  buffer_load_dwordx4 v[64:67], v23, s[20:23], s70 offen sc1
  s_add_u32 s70, s73, 32256
  buffer_load_dwordx4 v[68:71], v23, s[20:23], s70 offen sc1
  s_add_u32 s70, s73, 35840
  buffer_load_dwordx4 v[72:75], v23, s[20:23], s70 offen sc1
  s_add_u32 s70, s73, 39424
  buffer_load_dwordx4 v[76:79], v23, s[20:23], s70 offen sc1
  s_waitcnt vmcnt(0)
  v_xor_b32 v25, s82, v64
  v_xor_b32 v26, s84, v65
  v_bitop3_b32 v25, v25, v66, s78 bitop3:0xf6
  v_bitop3_b32 v26, v26, v67, s80 bitop3:0xf6
  v_bitop3_b32 v25, v25, v68, s82 bitop3:0xf6
  v_bitop3_b32 v26, v26, v69, s84 bitop3:0xf6
  v_bitop3_b32 v25, v25, v70, s78 bitop3:0xf6
  v_bitop3_b32 v26, v26, v71, s80 bitop3:0xf6
  v_bitop3_b32 v25, v25, v72, s82 bitop3:0xf6
  v_bitop3_b32 v26, v26, v73, s84 bitop3:0xf6
  v_bitop3_b32 v25, v25, v74, s78 bitop3:0xf6
  v_bitop3_b32 v26, v26, v75, s80 bitop3:0xf6
  v_bitop3_b32 v25, v25, v76, s82 bitop3:0xf6
  v_bitop3_b32 v26, v26, v77, s84 bitop3:0xf6
  v_bitop3_b32 v25, v25, v78, s78 bitop3:0xf6
  v_bitop3_b32 v26, v26, v79, s80 bitop3:0xf6
  v_or_b32 v25, v25, v26
  v_and_b32 v25, v24, v25
  v_cmp_ne_u32 vcc, 0, v25
  s_nop 0
  s_cbranch_vccnz B_r2
  s_branch B_r2r
B_r1:
  s_add_u32 s87, s87, 1
  s_cmp_ge_u32 s87, 4096
  s_cbranch_scc1 B_r1r
  s_add_u32 s70, s73, 14336
  buffer_load_dwordx4 v[80:83], v23, s[20:23], s70 offen sc1
  s_add_u32 s70, s73, 17920
  buffer_load_dwordx4 v[84:87], v23, s[20:23], s70 offen sc1
  s_add_u32 s70, s73, 21504
  buffer_load_dwordx4 v[88:91], v23, s[20:23], s70 offen sc1
  s_add_u32 s70, s73, 25088
  buffer_load_dwordx4 v[92:95], v23, s[20:23], s70 offen sc1
  s_waitcnt vmcnt(0)
  v_xor_b32 v25, s82, v80
  v_xor_b32 v26, s84, v81
  v_bitop3_b32 v25, v25, v82, s78 bitop3:0xf6
  v_bitop3_b32 v26, v26, v83, s80 bitop3:0xf6
  v_bitop3_b32 v25, v25, v84, s82 bitop3:0xf6
  v_bitop3_b32 v26, v26, v85, s84 bitop3:0xf6
  v_bitop3_b32 v25, v25, v86, s78 bitop3:0xf6
  v_bitop3_b32 v26, v26, v87, s80 bitop3:0xf6
  v_bitop3_b32 v25, v25, v88, s82 bitop3:0xf6
  v_bitop3_b32 v26, v26, v89, s84 bitop3:0xf6
  v_bitop3_b32 v25, v25, v90, s78 bitop3:0xf6
  v_bitop3_b32 v26, v26, v91, s80 bitop3:0xf6
  v_bitop3_b32 v25, v25, v92, s82 bitop3:0xf6
  v_bitop3_b32 v26, v26, v93, s84 bitop3:0xf6
  v_bitop3_b32 v25, v25, v94, s78 bitop3:0xf6
  v_bitop3_b32 v26, v26, v95, s80 bitop3:0xf6
  v_or_b32 v25, v25, v26
  v_and_b32 v25, v24, v25
  v_cmp_ne_u32 vcc, 0, v25
  s_nop 0
  s_cbranch_vccnz B_r1
  s_branch B_r1r
B_r0:
  s_add_u32 s87, s87, 1
  s_cmp_ge_u32 s87, 4096
  s_cbranch_scc1 B_r0r
  s_add_u32 s70, s73, 0
  buffer_load_dwordx4 v[96:99], v23, s[20:23], s70 offen sc1
  s_add_u32 s70, s73, 3584
  buffer_load_dwordx4 v[100:103], v23, s[20:23], s70 offen sc1
  s_add_u32 s70, s73, 7168
  buffer_load_dwordx4 v[104:107], v23, s[20:23], s70 offen sc1
  s_add_u32 s70, s73, 10752
  buffer_load_dwordx4 v[108:111], v23, s[20:23], s70 offen sc1
  s_waitcnt vmcnt(0)
  v_xor_b32 v25, s82, v96
  v_xor_b32 v26, s84, v97
  v_bitop3_b32 v25, v25, v98, s78 bitop3:0xf6
  v_bitop3_b32 v26, v26, v99, s80 bitop3:0xf6
  v_bitop3_b32 v25, v25, v100, s82 bitop3:0xf6
  v_bitop3_b32 v26, v26, v101, s84 bitop3:0xf6
  v_bitop3_b32 v25, v25, v102, s78 bitop3:0xf6
  v_bitop3_b32 v26, v26, v103, s80 bitop3:0xf6
  v_bitop3_b32 v25, v25, v104, s82 bitop3:0xf6
  v_bitop3_b32 v26, v26, v105, s84 bitop3:0xf6
  v_bitop3_b32 v25, v25, v106, s78 bitop3:0xf6
  v_bitop3_b32 v26, v26, v107, s80 bitop3:0xf6
  v_bitop3_b32 v25, v25, v108, s82 bitop3:0xf6
  v_bitop3_b32 v26, v26, v109, s84 bitop3:0xf6
  v_bitop3_b32 v25, v25, v110, s78 bitop3:0xf6
  v_bitop3_b32 v26, v26, v111, s80 bitop3:0xf6
  v_or_b32 v25, v25, v26
  v_and_b32 v25, v24, v25
  v_cmp_ne_u32 vcc, 0, v25
  s_nop 0
  s_cbranch_vccnz B_r0
  s_branch B_r0r
B_slow0:
  s_mov_b32 s87, 0
B_slow0l:
  s_and_b32 s71, s85, 0xfffffff0
  buffer_load_dword v24, off, s[32:35], s71 sc1
  s_waitcnt vmcnt(0)
  v_readfirstlane_b32 s70, v24
  s_and_b32 s70, s70, 0x01010101
  s_cmp_eq_u32 s70, 0x01010101
  s_cbranch_scc1 B_slow0r
  s_add_u32 s87, s87, 1
  s_cmp_lt_u32 s87, 131072
  s_cbranch_scc1 B_slow0l
  s_branch B_slow0r
B_slow1:
  s_lshl_b32 s72, s63, 2
  s_add_u32 s72, s72, 33554464
  s_mov_b32 s87, 0
  s_mov_b64 exec, 7
B_slow1l:
  buffer_load_dword v20, v21, s[20:23], s72 offen sc1
  s_waitcnt vmcnt(0)
  v_cmp_ne_u32 vcc, 0, v20
  s_cmp_eq_u32 vcc_lo, 7
  s_cbranch_scc1 B_slow1ld
  s_add_u32 s87, s87, 1
  s_cmp_lt_u32 s87, 131072
  s_cbranch_scc1 B_slow1l
B_slow1ld:
  s_mov_b64 exec, -1
  s_branch B_slow1r
B_slow2:
  s_lshl_b32 s72, s63, 2
  s_add_u32 s72, s72, 33554432
  s_mov_b32 s87, 0
  s_mov_b64 exec, 7
B_slow2l:
  buffer_load_dword v20, v21, s[20:23], s72 offen sc1
  s_waitcnt vmcnt(0)
  v_cmp_ne_u32 vcc, 0, v20
  s_cmp_eq_u32 vcc_lo, 7
  s_cbranch_scc1 B_slow2ld
  s_add_u32 s87, s87, 1
  s_cmp_lt_u32 s87, 131072
  s_cbranch_scc1 B_slow2l
B_slow2ld:
  s_mov_b64 exec, -1
  s_branch B_slow2r
L_end:
  s_endpgm
.section .rodata,"a"
.p2align 6
.amdhsa_kernel concat_heads__mha_block_cached__mha_block_cached__near_ridge_kernel
  .amdhsa_next_free_vgpr 256
  .amdhsa_next_free_sgpr 102
  .amdhsa_accum_offset 256
  .amdhsa_group_segment_fixed_size 0
  .amdhsa_kernarg_size 104
  .amdhsa_user_sgpr_count 2
  .amdhsa_user_sgpr_kernarg_segment_ptr 1
  .amdhsa_system_sgpr_workgroup_id_x 1
.end_amdhsa_kernel
```
